```python
import torch

def _softmax(x, axis=-1):
    return torch.softmax(x, dim=axis)
def _gelu(x):
    return torch.nn.functional.gelu(x, approximate="tanh")
def _silu(x):
    return torch.nn.functional.silu(x)
def _sigmoid(x):
    return torch.sigmoid(x)
def _layernorm(x, axis=-1, eps=1e-5):
    m = x.mean(dim=axis, keepdim=True)
    v = x.var(dim=axis, keepdim=True, unbiased=False)
    return (x - m) / torch.sqrt(v + eps)
def _scatter_add(tgt, idx, src, axis=0):
    return tgt.clone().index_add_(axis, idx, src)
def _segment_sum(src, seg, n):
    out = torch.zeros((n,) + src.shape[1:], dtype=src.dtype)
    return out.index_add_(0, seg, src)
def _pad(x, pw):
    flat = tuple(v for pair in reversed(pw) for v in pair)
    return torch.nn.functional.pad(x, flat)

kernel_name = 'recurrent_scan__sliding_block_cached__mixer_token_mlp__prompt'

def setup_inputs():

    _w = (lambda a: (lambda t: t.to(torch.bfloat16) if t.is_floating_point() else t)(torch.as_tensor(a)))
    def _A_setup():
        B, Sq, D = 1, 2048, 512
        Hq, Hkv, Sk, Dh = 32, 8, 2048, 128
        assert Hq % Hkv == 0, (Hq, Hkv)
        return {
            "x": _w((lambda *s: torch.randn(*s, dtype=torch.bfloat16) * 0.05)(B, Sq, D)),
            "k_cache": _w((lambda *s: torch.randn(*s, dtype=torch.bfloat16) * 1.6)(B, Hkv, Sk, Dh)),
            "v_cache": _w((lambda *s: torch.randn(*s, dtype=torch.bfloat16) * 0.8)(B, Hkv, Sk, Dh)),
            "wq": _w((lambda *s: torch.randn(*s, dtype=torch.bfloat16) * 1.6)(D, Hq * Dh) * (D ** -0.5)),
            "wo": _w((lambda *s: torch.randn(*s, dtype=torch.bfloat16) * 0.8)(Hq * Dh, D) * ((Hq * Dh) ** -0.5)),
        }
    _A_in = _A_setup()

    def _B_setup():
        B, S, D, F = 1, 2048, 512, 1792
        return {
            "x": _w((lambda *s: torch.randn(*s, dtype=torch.bfloat16) * 0.05)(B, S, D)),
            "w1": _w((lambda *s: torch.randn(*s, dtype=torch.bfloat16) * 1.6)(S, F) * (S ** -0.5)),
            "b1": _w((lambda *s: torch.randn(*s, dtype=torch.bfloat16) * 1.6)(F) * 0.02),
            "w2": _w((lambda *s: torch.randn(*s, dtype=torch.bfloat16) * 0.2)(F, S) * (F ** -0.5)),
            "b2": _w((lambda *s: torch.randn(*s, dtype=torch.bfloat16) * 0.2)(S) * 0.02),
        }
    _B_in = _B_setup()

    return {
        "A_x": _A_in["x"],
        "A_k_cache": _A_in["k_cache"],
        "A_v_cache": _A_in["v_cache"],
        "A_wq": _A_in["wq"],
        "A_wo": _A_in["wo"],
        "B_x": _B_in["x"],
        "B_w1": _B_in["w1"],
        "B_b1": _B_in["b1"],
        "B_w2": _B_in["w2"],
        "B_b2": _B_in["b2"],
    }

def reference(A_x, A_k_cache, A_v_cache, A_wq, A_wo, B_x, B_w1, B_b1, B_w2, B_b2):
    def _A_ref(x, k_cache, v_cache, wq, wo):
        B, Sq, D = x.shape
        Hq, Dh = 32, 128
        Hkv, Sk = k_cache.shape[1], k_cache.shape[2]
        W = min(4096, max(256, Sk // 4))
        rep = Hq // Hkv
        q = (lambda x, *d: x.permute(*d))((x @ wq).reshape(B, Sq, Hq, Dh), 0, 2, 1, 3)
        k = (lambda x, n, axis: torch.repeat_interleave(x, n, dim=axis))(k_cache[:, :, Sk - W:, :], rep, axis=1)
        v = (lambda x, n, axis: torch.repeat_interleave(x, n, dim=axis))(v_cache[:, :, Sk - W:, :], rep, axis=1)
        scores = torch.einsum("bhqd,bhkd->bhqk", q, k) * (Dh ** -0.5)
        p = _softmax(scores, axis=-1)
        o = torch.einsum("bhqk,bhkd->bhqd", p, v)
        return (lambda x, *d: x.permute(*d))(o, 0, 2, 1, 3).reshape(B, Sq, Hq * Dh) @ wo

    def _B_ref(x, w1, b1, w2, b2):
        B, S, D = x.shape
        h = _layernorm(x, axis=-1)
        u = torch.einsum("bsd,sf->bdf", h, w1) + b1
        u = _gelu(u)
        y = torch.einsum("bdf,fs->bds", u, w2) + b2
        return (lambda x, *d: x.permute(*d))(y, 0, 2, 1)

    x = A_x
    xn = _layernorm(x, axis=-1)
    s = _A_ref(xn, A_k_cache, A_v_cache, A_wq, A_wo)
    g = _silu(_B_ref(xn, B_w1, B_b1, B_w2, B_b2))
    return x + s * g
```

```asm
; @launch kernel=ln_kernel grid=(256,1,1) block=(256,1,1) lds=8192
; @launch kernel=main_kernel grid=(256,1,1) block=(512,1,1) lds=163840
.amdgcn_target "amdgcn-amd-amdhsa--gfx950"
.text
.globl ln_kernel
.p2align 8
.type ln_kernel,@function
ln_kernel:
    s_cmp_ge_u32 s2, 256
    s_cbranch_scc1 L_ln_done
    s_load_dwordx2 s[4:5], s[0:1], 0
    s_load_dwordx2 s[6:7], s[0:1], 96
    s_load_dwordx4 s[24:27], s[0:1], 8
    s_load_dwordx2 s[28:29], s[0:1], 24
    v_lshrrev_b32 v3, 6, v0
    v_and_b32 v1, 63, v0
    v_readfirstlane_b32 s3, v3
    v_lshlrev_b32 v2, 4, v1
    s_lshr_b32 s16, s2, 1
    s_and_b32 s17, s2, 1
    s_lshl_b32 s18, s16, 4
    s_lshl2_add_u32 s18, s17, s18
    s_and_b32 s19, s3, 1
    s_lshl1_add_u32 s18, s19, s18
    s_lshr_b32 s19, s3, 1
    s_lshl3_add_u32 s18, s19, s18
    s_lshl_b32 s19, s18, 10
    s_waitcnt lgkmcnt(0)
    s_mov_b32 s8, s4
    s_and_b32 s9, s5, 0xffff
    s_mov_b32 s10, 0x200000
    s_mov_b32 s11, 0x20000
    s_mov_b32 s12, s6
    s_and_b32 s13, s7, 0xffff
    s_mov_b32 s14, 0x10000000
    s_mov_b32 s15, 0x20000
    buffer_load_dwordx4 v[8:11], v2, s[8:11], s19 offen
    buffer_load_dwordx4 v[12:15], v2, s[8:11], s19 offen offset:1024
    s_mov_b32 s32, s24
    s_and_b32 s33, s25, 0xffff
    s_mov_b32 s34, 0x400000
    s_mov_b32 s35, 0x20000
    s_mov_b32 s36, s26
    s_and_b32 s37, s27, 0xffff
    s_mov_b32 s38, 0x400000
    s_mov_b32 s39, 0x20000
    s_mov_b32 s40, s28
    s_and_b32 s41, s29, 0xffff
    s_mov_b32 s42, 0x400000
    s_mov_b32 s43, 0x20000
    s_lshl2_add_u32 s30, s2, s3
    s_lshl_b32 s31, s30, 12
    buffer_load_dwordx4 v[16:19], v2, s[40:43], s31 offen offset:0
    buffer_load_dwordx4 v[20:23], v2, s[40:43], s31 offen offset:1024
    buffer_load_dwordx4 v[24:27], v2, s[40:43], s31 offen offset:2048
    buffer_load_dwordx4 v[28:31], v2, s[40:43], s31 offen offset:3072
    s_lshr_b32 s31, s30, 7
    s_lshl_b32 s31, s31, 19
    s_and_b32 s30, s30, 127
    s_lshl_b32 s30, s30, 10
    s_add_u32 s31, s31, s30
    s_add_u32 s31, s31, 393216
    buffer_load_dwordx4 v[32:35], v2, s[32:35], s31 offen
    buffer_load_dwordx4 v[36:39], v2, s[36:39], s31 offen
    v_mov_b32 v3, 0
    v_and_b32 v4, 3, v1
    v_lshlrev_b32 v4, 15, v4
    s_lshl_b32 s31, s2, 7
    s_add_u32 s31, s31, 25165824
    buffer_store_dword v3, v4, s[12:15], s31 offen
    v_lshrrev_b32 v3, 1, v1
    v_lshlrev_b32 v3, 10, v3
    v_and_b32 v4, 1, v1
    v_lshl_add_u32 v4, v4, 3, v3
    s_lshr_b32 s20, s18, 5
    s_lshl_b32 s20, s20, 15
    s_and_b32 s21, s18, 31
    s_lshl4_add_u32 s20, s21, s20
    s_add_u32 s20, s20, 0
    s_waitcnt vmcnt(8)
    v_lshlrev_b32 v40, 16, v8
    s_waitcnt vmcnt(7)
    v_lshlrev_b32 v56, 16, v12
    v_and_b32 v41, 0xffff0000, v8
    v_and_b32 v57, 0xffff0000, v12
    v_lshlrev_b32 v42, 16, v9
    v_lshlrev_b32 v58, 16, v13
    v_and_b32 v43, 0xffff0000, v9
    v_and_b32 v59, 0xffff0000, v13
    v_lshlrev_b32 v44, 16, v10
    v_lshlrev_b32 v60, 16, v14
    v_and_b32 v45, 0xffff0000, v10
    v_and_b32 v61, 0xffff0000, v14
    v_lshlrev_b32 v46, 16, v11
    v_lshlrev_b32 v62, 16, v15
    v_and_b32 v47, 0xffff0000, v11
    v_and_b32 v63, 0xffff0000, v15
    v_add_f32 v48, v40, v41
    v_add_f32 v64, v56, v57
    v_add_f32 v49, v42, v43
    v_add_f32 v65, v58, v59
    v_add_f32 v50, v44, v45
    v_add_f32 v66, v60, v61
    v_add_f32 v51, v46, v47
    v_add_f32 v67, v62, v63
    v_add_f32 v48, v48, v49
    v_add_f32 v64, v64, v65
    v_add_f32 v50, v50, v51
    v_add_f32 v66, v66, v67
    v_add_f32 v72, v48, v50
    v_add_f32 v75, v64, v66
    s_nop 0
    v_add_f32_dpp v72, v72, v72 row_ror:8 row_mask:0xf bank_mask:0xf
    v_add_f32_dpp v75, v75, v75 row_ror:8 row_mask:0xf bank_mask:0xf
    s_nop 0
    v_add_f32_dpp v72, v72, v72 row_ror:4 row_mask:0xf bank_mask:0xf
    v_add_f32_dpp v75, v75, v75 row_ror:4 row_mask:0xf bank_mask:0xf
    s_nop 0
    v_add_f32_dpp v72, v72, v72 row_ror:2 row_mask:0xf bank_mask:0xf
    v_add_f32_dpp v75, v75, v75 row_ror:2 row_mask:0xf bank_mask:0xf
    s_nop 0
    v_add_f32_dpp v72, v72, v72 row_ror:1 row_mask:0xf bank_mask:0xf
    v_add_f32_dpp v75, v75, v75 row_ror:1 row_mask:0xf bank_mask:0xf
    v_mov_b32 v74, v72
    v_mov_b32 v77, v75
    s_nop 0
    v_permlane16_swap_b32 v72, v74
    v_permlane16_swap_b32 v75, v77
    v_add_f32 v72, v72, v74
    v_add_f32 v75, v75, v77
    v_mov_b32 v74, v72
    v_mov_b32 v77, v75
    s_nop 0
    v_permlane32_swap_b32 v72, v74
    v_permlane32_swap_b32 v75, v77
    v_add_f32 v72, v72, v74
    v_add_f32 v75, v75, v77
    v_mul_f32 v72, 0x3b000000, v72
    v_mul_f32 v75, 0x3b000000, v75
    v_sub_f32 v48, v40, v72
    v_sub_f32 v64, v56, v75
    v_sub_f32 v49, v41, v72
    v_sub_f32 v65, v57, v75
    v_sub_f32 v50, v42, v72
    v_sub_f32 v66, v58, v75
    v_sub_f32 v51, v43, v72
    v_sub_f32 v67, v59, v75
    v_sub_f32 v52, v44, v72
    v_sub_f32 v68, v60, v75
    v_sub_f32 v53, v45, v72
    v_sub_f32 v69, v61, v75
    v_sub_f32 v54, v46, v72
    v_sub_f32 v70, v62, v75
    v_sub_f32 v55, v47, v72
    v_sub_f32 v71, v63, v75
    v_mul_f32 v73, v48, v48
    v_mul_f32 v76, v64, v64
    v_mul_f32 v74, v49, v49
    v_mul_f32 v77, v65, v65
    v_fmac_f32 v73, v50, v50
    v_fmac_f32 v76, v66, v66
    v_fmac_f32 v74, v51, v51
    v_fmac_f32 v77, v67, v67
    v_fmac_f32 v73, v52, v52
    v_fmac_f32 v76, v68, v68
    v_fmac_f32 v74, v53, v53
    v_fmac_f32 v77, v69, v69
    v_fmac_f32 v73, v54, v54
    v_fmac_f32 v76, v70, v70
    v_fmac_f32 v74, v55, v55
    v_fmac_f32 v77, v71, v71
    v_add_f32 v73, v73, v74
    v_add_f32 v76, v76, v77
    s_nop 0
    v_add_f32_dpp v73, v73, v73 row_ror:8 row_mask:0xf bank_mask:0xf
    v_add_f32_dpp v76, v76, v76 row_ror:8 row_mask:0xf bank_mask:0xf
    s_nop 0
    v_add_f32_dpp v73, v73, v73 row_ror:4 row_mask:0xf bank_mask:0xf
    v_add_f32_dpp v76, v76, v76 row_ror:4 row_mask:0xf bank_mask:0xf
    s_nop 0
    v_add_f32_dpp v73, v73, v73 row_ror:2 row_mask:0xf bank_mask:0xf
    v_add_f32_dpp v76, v76, v76 row_ror:2 row_mask:0xf bank_mask:0xf
    s_nop 0
    v_add_f32_dpp v73, v73, v73 row_ror:1 row_mask:0xf bank_mask:0xf
    v_add_f32_dpp v76, v76, v76 row_ror:1 row_mask:0xf bank_mask:0xf
    v_mov_b32 v74, v73
    v_mov_b32 v77, v76
    s_nop 0
    v_permlane16_swap_b32 v73, v74
    v_permlane16_swap_b32 v76, v77
    v_add_f32 v73, v73, v74
    v_add_f32 v76, v76, v77
    v_mov_b32 v74, v73
    v_mov_b32 v77, v76
    s_nop 0
    v_permlane32_swap_b32 v73, v74
    v_permlane32_swap_b32 v76, v77
    v_add_f32 v73, v73, v74
    v_add_f32 v76, v76, v77
    v_mul_f32 v73, 0x3b000000, v73
    v_mul_f32 v76, 0x3b000000, v76
    v_cvt_pk_bf16_f32 v74, v73, v73
    v_cvt_pk_bf16_f32 v77, v76, v76
    v_lshlrev_b32 v73, 16, v74
    v_lshlrev_b32 v76, 16, v77
    v_add_f32 v73, 0x3727c5ac, v73
    v_add_f32 v76, 0x3727c5ac, v76
    v_cvt_pk_bf16_f32 v74, v73, v73
    v_cvt_pk_bf16_f32 v77, v76, v76
    v_lshlrev_b32 v73, 16, v74
    v_lshlrev_b32 v76, 16, v77
    v_sqrt_f32 v73, v73
    v_sqrt_f32 v76, v76
    v_cvt_pk_bf16_f32 v74, v73, v73
    v_cvt_pk_bf16_f32 v77, v76, v76
    v_lshlrev_b32 v73, 16, v74
    v_lshlrev_b32 v76, 16, v77
    v_rcp_f32 v73, v73
    v_rcp_f32 v76, v76
    v_cvt_pk_bf16_f32 v74, v72, v72
    v_cvt_pk_bf16_f32 v77, v75, v75
    v_lshlrev_b32 v72, 16, v74
    v_lshlrev_b32 v75, 16, v77
    v_sub_f32 v48, v40, v72
    v_sub_f32 v64, v56, v75
    v_sub_f32 v49, v41, v72
    v_sub_f32 v65, v57, v75
    v_sub_f32 v50, v42, v72
    v_sub_f32 v66, v58, v75
    v_sub_f32 v51, v43, v72
    v_sub_f32 v67, v59, v75
    v_sub_f32 v52, v44, v72
    v_sub_f32 v68, v60, v75
    v_sub_f32 v53, v45, v72
    v_sub_f32 v69, v61, v75
    v_sub_f32 v54, v46, v72
    v_sub_f32 v70, v62, v75
    v_sub_f32 v55, v47, v72
    v_sub_f32 v71, v63, v75
    v_cvt_pk_bf16_f32 v40, v48, v49
    v_cvt_pk_bf16_f32 v56, v64, v65
    v_cvt_pk_bf16_f32 v41, v50, v51
    v_cvt_pk_bf16_f32 v57, v66, v67
    v_cvt_pk_bf16_f32 v42, v52, v53
    v_cvt_pk_bf16_f32 v58, v68, v69
    v_cvt_pk_bf16_f32 v43, v54, v55
    v_cvt_pk_bf16_f32 v59, v70, v71
    v_lshlrev_b32 v48, 16, v40
    v_lshlrev_b32 v64, 16, v56
    v_and_b32 v49, 0xffff0000, v40
    v_and_b32 v65, 0xffff0000, v56
    v_lshlrev_b32 v50, 16, v41
    v_lshlrev_b32 v66, 16, v57
    v_and_b32 v51, 0xffff0000, v41
    v_and_b32 v67, 0xffff0000, v57
    v_lshlrev_b32 v52, 16, v42
    v_lshlrev_b32 v68, 16, v58
    v_and_b32 v53, 0xffff0000, v42
    v_and_b32 v69, 0xffff0000, v58
    v_lshlrev_b32 v54, 16, v43
    v_lshlrev_b32 v70, 16, v59
    v_and_b32 v55, 0xffff0000, v43
    v_and_b32 v71, 0xffff0000, v59
    v_mul_f32 v48, v48, v73
    v_mul_f32 v64, v64, v76
    v_mul_f32 v49, v49, v73
    v_mul_f32 v65, v65, v76
    v_mul_f32 v50, v50, v73
    v_mul_f32 v66, v66, v76
    v_mul_f32 v51, v51, v73
    v_mul_f32 v67, v67, v76
    v_mul_f32 v52, v52, v73
    v_mul_f32 v68, v68, v76
    v_mul_f32 v53, v53, v73
    v_mul_f32 v69, v69, v76
    v_mul_f32 v54, v54, v73
    v_mul_f32 v70, v70, v76
    v_mul_f32 v55, v55, v73
    v_mul_f32 v71, v71, v76
    v_cvt_pk_bf16_f32 v8, v48, v49
    v_cvt_pk_bf16_f32 v12, v64, v65
    v_cvt_pk_bf16_f32 v9, v50, v51
    v_cvt_pk_bf16_f32 v13, v66, v67
    v_cvt_pk_bf16_f32 v10, v52, v53
    v_cvt_pk_bf16_f32 v14, v68, v69
    v_cvt_pk_bf16_f32 v11, v54, v55
    v_cvt_pk_bf16_f32 v15, v70, v71
    buffer_store_dwordx2 v[8:9], v4, s[12:15], s20 offen
    buffer_store_dwordx2 v[10:11], v4, s[12:15], s20 offen offset:512
    buffer_store_dwordx2 v[12:13], v4, s[12:15], s20 offen offset:16
    buffer_store_dwordx2 v[14:15], v4, s[12:15], s20 offen offset:528
    v_lshlrev_b32 v40, 16, v8
    v_lshlrev_b32 v56, 16, v12
    v_and_b32 v41, 0xffff0000, v8
    v_and_b32 v57, 0xffff0000, v12
    v_lshlrev_b32 v42, 16, v9
    v_lshlrev_b32 v58, 16, v13
    v_and_b32 v43, 0xffff0000, v9
    v_and_b32 v59, 0xffff0000, v13
    v_lshlrev_b32 v44, 16, v10
    v_lshlrev_b32 v60, 16, v14
    v_and_b32 v45, 0xffff0000, v10
    v_and_b32 v61, 0xffff0000, v14
    v_lshlrev_b32 v46, 16, v11
    v_lshlrev_b32 v62, 16, v15
    v_and_b32 v47, 0xffff0000, v11
    v_and_b32 v63, 0xffff0000, v15
    v_add_f32 v48, v40, v41
    v_add_f32 v64, v56, v57
    v_add_f32 v49, v42, v43
    v_add_f32 v65, v58, v59
    v_add_f32 v50, v44, v45
    v_add_f32 v66, v60, v61
    v_add_f32 v51, v46, v47
    v_add_f32 v67, v62, v63
    v_add_f32 v48, v48, v49
    v_add_f32 v64, v64, v65
    v_add_f32 v50, v50, v51
    v_add_f32 v66, v66, v67
    v_add_f32 v72, v48, v50
    v_add_f32 v75, v64, v66
    s_nop 0
    v_add_f32_dpp v72, v72, v72 row_ror:8 row_mask:0xf bank_mask:0xf
    v_add_f32_dpp v75, v75, v75 row_ror:8 row_mask:0xf bank_mask:0xf
    s_nop 0
    v_add_f32_dpp v72, v72, v72 row_ror:4 row_mask:0xf bank_mask:0xf
    v_add_f32_dpp v75, v75, v75 row_ror:4 row_mask:0xf bank_mask:0xf
    s_nop 0
    v_add_f32_dpp v72, v72, v72 row_ror:2 row_mask:0xf bank_mask:0xf
    v_add_f32_dpp v75, v75, v75 row_ror:2 row_mask:0xf bank_mask:0xf
    s_nop 0
    v_add_f32_dpp v72, v72, v72 row_ror:1 row_mask:0xf bank_mask:0xf
    v_add_f32_dpp v75, v75, v75 row_ror:1 row_mask:0xf bank_mask:0xf
    v_mov_b32 v74, v72
    v_mov_b32 v77, v75
    s_nop 0
    v_permlane16_swap_b32 v72, v74
    v_permlane16_swap_b32 v75, v77
    v_add_f32 v72, v72, v74
    v_add_f32 v75, v75, v77
    v_mov_b32 v74, v72
    v_mov_b32 v77, v75
    s_nop 0
    v_permlane32_swap_b32 v72, v74
    v_permlane32_swap_b32 v75, v77
    v_add_f32 v72, v72, v74
    v_add_f32 v75, v75, v77
    v_mul_f32 v72, 0x3b000000, v72
    v_mul_f32 v75, 0x3b000000, v75
    v_sub_f32 v48, v40, v72
    v_sub_f32 v64, v56, v75
    v_sub_f32 v49, v41, v72
    v_sub_f32 v65, v57, v75
    v_sub_f32 v50, v42, v72
    v_sub_f32 v66, v58, v75
    v_sub_f32 v51, v43, v72
    v_sub_f32 v67, v59, v75
    v_sub_f32 v52, v44, v72
    v_sub_f32 v68, v60, v75
    v_sub_f32 v53, v45, v72
    v_sub_f32 v69, v61, v75
    v_sub_f32 v54, v46, v72
    v_sub_f32 v70, v62, v75
    v_sub_f32 v55, v47, v72
    v_sub_f32 v71, v63, v75
    v_mul_f32 v73, v48, v48
    v_mul_f32 v76, v64, v64
    v_mul_f32 v74, v49, v49
    v_mul_f32 v77, v65, v65
    v_fmac_f32 v73, v50, v50
    v_fmac_f32 v76, v66, v66
    v_fmac_f32 v74, v51, v51
    v_fmac_f32 v77, v67, v67
    v_fmac_f32 v73, v52, v52
    v_fmac_f32 v76, v68, v68
    v_fmac_f32 v74, v53, v53
    v_fmac_f32 v77, v69, v69
    v_fmac_f32 v73, v54, v54
    v_fmac_f32 v76, v70, v70
    v_fmac_f32 v74, v55, v55
    v_fmac_f32 v77, v71, v71
    v_add_f32 v73, v73, v74
    v_add_f32 v76, v76, v77
    s_nop 0
    v_add_f32_dpp v73, v73, v73 row_ror:8 row_mask:0xf bank_mask:0xf
    v_add_f32_dpp v76, v76, v76 row_ror:8 row_mask:0xf bank_mask:0xf
    s_nop 0
    v_add_f32_dpp v73, v73, v73 row_ror:4 row_mask:0xf bank_mask:0xf
    v_add_f32_dpp v76, v76, v76 row_ror:4 row_mask:0xf bank_mask:0xf
    s_nop 0
    v_add_f32_dpp v73, v73, v73 row_ror:2 row_mask:0xf bank_mask:0xf
    v_add_f32_dpp v76, v76, v76 row_ror:2 row_mask:0xf bank_mask:0xf
    s_nop 0
    v_add_f32_dpp v73, v73, v73 row_ror:1 row_mask:0xf bank_mask:0xf
    v_add_f32_dpp v76, v76, v76 row_ror:1 row_mask:0xf bank_mask:0xf
    v_mov_b32 v74, v73
    v_mov_b32 v77, v76
    s_nop 0
    v_permlane16_swap_b32 v73, v74
    v_permlane16_swap_b32 v76, v77
    v_add_f32 v73, v73, v74
    v_add_f32 v76, v76, v77
    v_mov_b32 v74, v73
    v_mov_b32 v77, v76
    s_nop 0
    v_permlane32_swap_b32 v73, v74
    v_permlane32_swap_b32 v76, v77
    v_add_f32 v73, v73, v74
    v_add_f32 v76, v76, v77
    v_mul_f32 v73, 0x3b000000, v73
    v_mul_f32 v76, 0x3b000000, v76
    v_cvt_pk_bf16_f32 v74, v73, v73
    v_cvt_pk_bf16_f32 v77, v76, v76
    v_lshlrev_b32 v73, 16, v74
    v_lshlrev_b32 v76, 16, v77
    v_add_f32 v73, 0x3727c5ac, v73
    v_add_f32 v76, 0x3727c5ac, v76
    v_cvt_pk_bf16_f32 v74, v73, v73
    v_cvt_pk_bf16_f32 v77, v76, v76
    v_lshlrev_b32 v73, 16, v74
    v_lshlrev_b32 v76, 16, v77
    v_sqrt_f32 v73, v73
    v_sqrt_f32 v76, v76
    v_cvt_pk_bf16_f32 v74, v73, v73
    v_cvt_pk_bf16_f32 v77, v76, v76
    v_lshlrev_b32 v73, 16, v74
    v_lshlrev_b32 v76, 16, v77
    v_rcp_f32 v73, v73
    v_rcp_f32 v76, v76
    v_cvt_pk_bf16_f32 v74, v72, v72
    v_cvt_pk_bf16_f32 v77, v75, v75
    v_lshlrev_b32 v72, 16, v74
    v_lshlrev_b32 v75, 16, v77
    v_sub_f32 v48, v40, v72
    v_sub_f32 v64, v56, v75
    v_sub_f32 v49, v41, v72
    v_sub_f32 v65, v57, v75
    v_sub_f32 v50, v42, v72
    v_sub_f32 v66, v58, v75
    v_sub_f32 v51, v43, v72
    v_sub_f32 v67, v59, v75
    v_sub_f32 v52, v44, v72
    v_sub_f32 v68, v60, v75
    v_sub_f32 v53, v45, v72
    v_sub_f32 v69, v61, v75
    v_sub_f32 v54, v46, v72
    v_sub_f32 v70, v62, v75
    v_sub_f32 v55, v47, v72
    v_sub_f32 v71, v63, v75
    v_cvt_pk_bf16_f32 v40, v48, v49
    v_cvt_pk_bf16_f32 v56, v64, v65
    v_cvt_pk_bf16_f32 v41, v50, v51
    v_cvt_pk_bf16_f32 v57, v66, v67
    v_cvt_pk_bf16_f32 v42, v52, v53
    v_cvt_pk_bf16_f32 v58, v68, v69
    v_cvt_pk_bf16_f32 v43, v54, v55
    v_cvt_pk_bf16_f32 v59, v70, v71
    v_lshlrev_b32 v48, 16, v40
    v_lshlrev_b32 v64, 16, v56
    v_and_b32 v49, 0xffff0000, v40
    v_and_b32 v65, 0xffff0000, v56
    v_lshlrev_b32 v50, 16, v41
    v_lshlrev_b32 v66, 16, v57
    v_and_b32 v51, 0xffff0000, v41
    v_and_b32 v67, 0xffff0000, v57
    v_lshlrev_b32 v52, 16, v42
    v_lshlrev_b32 v68, 16, v58
    v_and_b32 v53, 0xffff0000, v42
    v_and_b32 v69, 0xffff0000, v58
    v_lshlrev_b32 v54, 16, v43
    v_lshlrev_b32 v70, 16, v59
    v_and_b32 v55, 0xffff0000, v43
    v_and_b32 v71, 0xffff0000, v59
    v_mul_f32 v48, v48, v73
    v_mul_f32 v64, v64, v76
    v_mul_f32 v49, v49, v73
    v_mul_f32 v65, v65, v76
    v_mul_f32 v50, v50, v73
    v_mul_f32 v66, v66, v76
    v_mul_f32 v51, v51, v73
    v_mul_f32 v67, v67, v76
    v_mul_f32 v52, v52, v73
    v_mul_f32 v68, v68, v76
    v_mul_f32 v53, v53, v73
    v_mul_f32 v69, v69, v76
    v_mul_f32 v54, v54, v73
    v_mul_f32 v70, v70, v76
    v_mul_f32 v55, v55, v73
    v_mul_f32 v71, v71, v76
    v_cvt_pk_bf16_f32 v80, v48, v49
    v_cvt_pk_bf16_f32 v84, v64, v65
    v_cvt_pk_bf16_f32 v81, v50, v51
    v_cvt_pk_bf16_f32 v85, v66, v67
    v_cvt_pk_bf16_f32 v82, v52, v53
    v_cvt_pk_bf16_f32 v86, v68, v69
    v_cvt_pk_bf16_f32 v83, v54, v55
    v_cvt_pk_bf16_f32 v87, v70, v71
    v_lshl_add_u32 v3, s3, 11, v2
    ds_write_b128 v3, v[80:83]
    ds_write_b128 v3, v[84:87] offset:1024
    v_bfe_u32 v88, v1, 2, 2
    v_lshlrev_b32 v88, 10, v88
    v_lshrrev_b32 v89, 4, v1
    v_lshl_add_u32 v88, v89, 5, v88
    v_and_b32 v89, 3, v1
    v_lshl_add_u32 v88, v89, 3, v88
    v_lshl_add_u32 v88, s3, 8, v88
    v_lshrrev_b32 v89, 5, v1
    v_lshlrev_b32 v89, 17, v89
    v_and_b32 v3, 31, v1
    v_lshl_add_u32 v89, v3, 4, v89
    s_lshl_b32 s22, s3, 19
    s_lshl_b32 s23, s16, 10
    s_add_u32 s22, s22, s23
    s_lshl_b32 s23, s17, 9
    s_add_u32 s22, s22, s23
    s_add_u32 s22, s22, 2097152
    s_add_u32 s23, s22, 262144
    s_waitcnt lgkmcnt(0)
    s_barrier
    ds_read_b64_tr_b16 v[40:41], v88
    ds_read_b64_tr_b16 v[42:43], v88 offset:4096
    ds_read_b64_tr_b16 v[48:49], v88 offset:128
    ds_read_b64_tr_b16 v[50:51], v88 offset:4224
    s_waitcnt lgkmcnt(2)
    buffer_store_dwordx4 v[40:43], v89, s[12:15], s22 offen
    s_waitcnt lgkmcnt(0)
    buffer_store_dwordx4 v[48:51], v89, s[12:15], s23 offen
L_ln_done:
    s_endpgm
.section .rodata,"a"
.p2align 6
.amdhsa_kernel ln_kernel
  .amdhsa_next_free_vgpr 90
  .amdhsa_next_free_sgpr 44
  .amdhsa_accum_offset 92
  .amdhsa_group_segment_fixed_size 0
  .amdhsa_kernarg_size 104
  .amdhsa_user_sgpr_count 2
  .amdhsa_user_sgpr_kernarg_segment_ptr 1
  .amdhsa_system_sgpr_workgroup_id_x 1
.end_amdhsa_kernel
.text
.globl main_kernel
.p2align 8
.type main_kernel,@function
main_kernel:
    s_cmp_ge_u32 s2, 256
    s_cbranch_scc1 L_done
    s_load_dwordx2 s[4:5], s[0:1], 24
    s_load_dwordx2 s[6:7], s[0:1], 96
    s_load_dwordx4 s[16:19], s[0:1], 8
    s_load_dwordx2 s[48:49], s[0:1], 32
    s_load_dwordx2 s[52:53], s[0:1], 48
    s_load_dwordx2 s[56:57], s[0:1], 64
    v_lshrrev_b32 v3, 6, v0
    v_and_b32 v1, 63, v0
    v_readfirstlane_b32 s3, v3
    v_lshlrev_b32 v2, 4, v1
    s_and_b32 s30, s2, 7
    s_bfe_u32 s28, s2, 0x20003
    s_lshl2_add_u32 s28, s30, s28
    s_lshr_b32 s29, s2, 5
    s_lshl3_add_u32 s31, s29, s3
    s_lshl_b32 s41, s3, 11
    s_lshl_b32 s32, s3, 16
    s_lshl_b32 s37, s28, 8
    s_add_u32 s32, s32, s37
    s_lshl_b32 s33, s30, 19
    s_add_u32 s43, s33, 524288
    s_add_u32 s33, s33, s41
    s_add_u32 s33, s33, 393216
    s_mov_b32 s34, s33
    s_mov_b32 s44, 0x40000000
    s_mov_b32 s35, s41
    s_add_u32 s36, s41, 16384
    s_mov_b32 s39, 0x3e0293ee
    s_mov_b32 s40, 0x41000000
    s_lshl_b32 s42, s31, 15
    s_add_u32 s42, s42, 0
    v_lshrrev_b32 v3, 4, v1
    v_and_b32 v4, 15, v1
    v_lshlrev_b32 v5, 2, v3
    v_xor_b32 v5, v5, v4
    v_lshlrev_b32 v5, 4, v5
    v_lshl_add_u32 v9, v3, 8, v5
    v_lshl_add_u32 v5, v3, 13, v5
    v_add_u32 v6, 31744, v5
    s_waitcnt lgkmcnt(0)
    s_mov_b32 s8, s4
    s_and_b32 s9, s5, 0xffff
    s_mov_b32 s10, 0x400000
    s_mov_b32 s11, 0x20000
    s_mov_b32 s12, s6
    s_and_b32 s13, s7, 0xffff
    s_mov_b32 s14, 0x10000000
    s_mov_b32 s15, 0x20000
    s_add_u32 m0, s41, 0
    s_add_u32 s45, s32, 0
    buffer_load_dwordx4 v5, s[8:11], s45 offen lds
    buffer_load_dwordx4 v6, s[8:11], s45 offen offset:1024 lds
    s_add_u32 m0, s41, 16384
    s_add_u32 s45, s32, 524288
    buffer_load_dwordx4 v5, s[8:11], s45 offen lds
    buffer_load_dwordx4 v6, s[8:11], s45 offen offset:1024 lds
    s_add_u32 m0, s41, 32768
    s_add_u32 s45, s32, 1048576
    buffer_load_dwordx4 v5, s[8:11], s45 offen lds
    buffer_load_dwordx4 v6, s[8:11], s45 offen offset:1024 lds
    s_add_u32 m0, s41, 49152
    s_add_u32 s45, s32, 1572864
    buffer_load_dwordx4 v5, s[8:11], s45 offen lds
    buffer_load_dwordx4 v6, s[8:11], s45 offen offset:1024 lds
    s_add_u32 s46, s42, 0
    buffer_load_dwordx4 v[128:131], v2, s[12:15], s46 offen offset:0
    buffer_load_dwordx4 v[132:135], v2, s[12:15], s46 offen offset:1024
    buffer_load_dwordx4 v[136:139], v2, s[12:15], s46 offen offset:2048
    buffer_load_dwordx4 v[140:143], v2, s[12:15], s46 offen offset:3072
    s_add_u32 s46, s42, 4096
    buffer_load_dwordx4 v[144:147], v2, s[12:15], s46 offen offset:0
    buffer_load_dwordx4 v[148:151], v2, s[12:15], s46 offen offset:1024
    buffer_load_dwordx4 v[152:155], v2, s[12:15], s46 offen offset:2048
    buffer_load_dwordx4 v[156:159], v2, s[12:15], s46 offen offset:3072
    s_mov_b32 s20, s16
    s_and_b32 s21, s17, 0xffff
    s_mov_b32 s22, 0x400000
    s_mov_b32 s23, 0x20000
    s_mov_b32 s24, s18
    s_and_b32 s25, s19, 0xffff
    s_mov_b32 s26, 0x400000
    s_mov_b32 s27, 0x20000
    s_mov_b32 s48, s48
    s_and_b32 s49, s49, 0xffff
    s_mov_b32 s50, 0x400000
    s_mov_b32 s51, 0x20000
    s_mov_b32 s52, s52
    s_and_b32 s53, s53, 0xffff
    s_mov_b32 s54, 0x700000
    s_mov_b32 s55, 0x20000
    s_mov_b32 s56, s56
    s_and_b32 s57, s57, 0xffff
    s_mov_b32 s58, 0x700000
    s_mov_b32 s59, 0x20000
    s_lshl3_add_u32 s60, s2, s3
    s_mul_i32 s61, s60, 3584
    s_lshl_b32 s60, s60, 11
    s_add_u32 s47, s41, 131072
    s_and_b32 s37, s3, 1
    s_lshl_b32 s37, s37, 3
    v_add_u32 v7, s37, v3
    v_add_u32 v8, 4, v7
    v_xor_b32 v7, v7, v4
    v_xor_b32 v8, v8, v4
    v_lshlrev_b32 v7, 4, v7
    v_lshlrev_b32 v8, 4, v8
    v_lshl_add_u32 v7, v3, 8, v7
    v_lshl_add_u32 v8, v3, 8, v8
    v_lshrrev_b32 v3, 5, v1
    v_lshlrev_b32 v3, 10, v3
    v_bfe_u32 v4, v1, 2, 2
    v_lshl_add_u32 v3, v4, 8, v3
    v_lshl_add_u32 v3, v4, 6, v3
    v_bfe_u32 v4, v1, 4, 1
    v_lshl_add_u32 v3, v4, 5, v3
    v_and_b32 v4, 3, v1
    v_lshl_add_u32 v15, v4, 3, v3
    v_xor_b32 v16, 64, v15
    v_xor_b32 v17, 128, v15
    v_xor_b32 v18, 192, v15
    v_xor_b32 v19, 0x10000, v15
    v_xor_b32 v20, 0x10000, v16
    v_xor_b32 v21, 0x10000, v17
    v_xor_b32 v22, 0x10000, v18
    v_mov_b32 v11, 0
    v_mov_b32 v12, 0
    s_waitcnt vmcnt(8)
    s_barrier
    ds_read_b64_tr_b16 v[32:33], v15 offset:0
    ds_read_b64_tr_b16 v[34:35], v15 offset:2048
    ds_read_b64_tr_b16 v[36:37], v16 offset:0
    ds_read_b64_tr_b16 v[38:39], v16 offset:2048
    ds_read_b64_tr_b16 v[40:41], v17 offset:0
    ds_read_b64_tr_b16 v[42:43], v17 offset:2048
    ds_read_b64_tr_b16 v[44:45], v18 offset:0
    ds_read_b64_tr_b16 v[46:47], v18 offset:2048
    ds_read_b64_tr_b16 v[48:49], v15 offset:4096
    ds_read_b64_tr_b16 v[50:51], v15 offset:6144
    ds_read_b64_tr_b16 v[52:53], v16 offset:4096
    ds_read_b64_tr_b16 v[54:55], v16 offset:6144
    ds_read_b64_tr_b16 v[56:57], v17 offset:4096
    ds_read_b64_tr_b16 v[58:59], v17 offset:6144
    s_waitcnt vmcnt(7) lgkmcnt(12)
    v_mfma_f32_32x32x16_bf16 v[64:79], v[32:35], v[128:131], 0
    s_add_u32 m0, s41, 65536
    s_add_u32 s45, s32, 2097152
    buffer_load_dwordx4 v5, s[8:11], s45 offen lds
    ds_read_b64_tr_b16 v[60:61], v18 offset:4096
    ds_read_b64_tr_b16 v[62:63], v18 offset:6144
    s_waitcnt lgkmcnt(12)
    v_mfma_f32_32x32x16_bf16 v[80:95], v[36:39], v[128:131], 0
    ds_read_b64_tr_b16 v[32:33], v15 offset:8192
    ds_read_b64_tr_b16 v[34:35], v15 offset:10240
    s_waitcnt lgkmcnt(12)
    v_mfma_f32_32x32x16_bf16 v[96:111], v[40:43], v[128:131], 0
    buffer_load_dwordx4 v6, s[8:11], s45 offen offset:1024 lds
    ds_read_b64_tr_b16 v[36:37], v16 offset:8192
    ds_read_b64_tr_b16 v[38:39], v16 offset:10240
    s_waitcnt lgkmcnt(12)
    v_mfma_f32_32x32x16_bf16 v[112:127], v[44:47], v[128:131], 0
    ds_read_b64_tr_b16 v[40:41], v17 offset:8192
    ds_read_b64_tr_b16 v[42:43], v17 offset:10240
    s_waitcnt vmcnt(8) lgkmcnt(12)
    v_mfma_f32_32x32x16_bf16 v[64:79], v[48:51], v[132:135], v[64:79]
    s_add_u32 m0, s41, 81920
    s_add_u32 s45, s32, 2621440
    buffer_load_dwordx4 v5, s[8:11], s45 offen lds
    ds_read_b64_tr_b16 v[44:45], v18 offset:8192
    ds_read_b64_tr_b16 v[46:47], v18 offset:10240
    s_waitcnt lgkmcnt(12)
    v_mfma_f32_32x32x16_bf16 v[80:95], v[52:55], v[132:135], v[80:95]
    ds_read_b64_tr_b16 v[48:49], v15 offset:12288
    ds_read_b64_tr_b16 v[50:51], v15 offset:14336
    s_waitcnt lgkmcnt(12)
    v_mfma_f32_32x32x16_bf16 v[96:111], v[56:59], v[132:135], v[96:111]
    buffer_load_dwordx4 v6, s[8:11], s45 offen offset:1024 lds
    ds_read_b64_tr_b16 v[52:53], v16 offset:12288
    ds_read_b64_tr_b16 v[54:55], v16 offset:14336
    s_waitcnt lgkmcnt(12)
    v_mfma_f32_32x32x16_bf16 v[112:127], v[60:63], v[132:135], v[112:127]
    ds_read_b64_tr_b16 v[56:57], v17 offset:12288
    ds_read_b64_tr_b16 v[58:59], v17 offset:14336
    s_waitcnt vmcnt(9) lgkmcnt(12)
    v_mfma_f32_32x32x16_bf16 v[64:79], v[32:35], v[136:139], v[64:79]
    s_add_u32 s46, s42, 8192
    buffer_load_dwordx4 v[160:163], v2, s[12:15], s46 offen offset:0
    ds_read_b64_tr_b16 v[60:61], v18 offset:12288
    ds_read_b64_tr_b16 v[62:63], v18 offset:14336
    s_waitcnt lgkmcnt(12)
    v_mfma_f32_32x32x16_bf16 v[80:95], v[36:39], v[136:139], v[80:95]
    ds_read_b64_tr_b16 v[32:33], v15 offset:16384
    ds_read_b64_tr_b16 v[34:35], v15 offset:18432
    s_waitcnt lgkmcnt(12)
    v_mfma_f32_32x32x16_bf16 v[96:111], v[40:43], v[136:139], v[96:111]
    buffer_load_dwordx4 v[164:167], v2, s[12:15], s46 offen offset:1024
    ds_read_b64_tr_b16 v[36:37], v16 offset:16384
    ds_read_b64_tr_b16 v[38:39], v16 offset:18432
    s_waitcnt lgkmcnt(12)
    v_mfma_f32_32x32x16_bf16 v[112:127], v[44:47], v[136:139], v[112:127]
    ds_read_b64_tr_b16 v[40:41], v17 offset:16384
    ds_read_b64_tr_b16 v[42:43], v17 offset:18432
    s_waitcnt vmcnt(10) lgkmcnt(12)
    v_mfma_f32_32x32x16_bf16 v[64:79], v[48:51], v[140:143], v[64:79]
    buffer_load_dwordx4 v[168:171], v2, s[12:15], s46 offen offset:2048
    ds_read_b64_tr_b16 v[44:45], v18 offset:16384
    ds_read_b64_tr_b16 v[46:47], v18 offset:18432
    s_waitcnt lgkmcnt(12)
    v_mfma_f32_32x32x16_bf16 v[80:95], v[52:55], v[140:143], v[80:95]
    ds_read_b64_tr_b16 v[48:49], v15 offset:20480
    ds_read_b64_tr_b16 v[50:51], v15 offset:22528
    s_waitcnt lgkmcnt(12)
    v_mfma_f32_32x32x16_bf16 v[96:111], v[56:59], v[140:143], v[96:111]
    buffer_load_dwordx4 v[172:175], v2, s[12:15], s46 offen offset:3072
    ds_read_b64_tr_b16 v[52:53], v16 offset:20480
    ds_read_b64_tr_b16 v[54:55], v16 offset:22528
    s_waitcnt lgkmcnt(12)
    v_mfma_f32_32x32x16_bf16 v[112:127], v[60:63], v[140:143], v[112:127]
    ds_read_b64_tr_b16 v[56:57], v17 offset:20480
    ds_read_b64_tr_b16 v[58:59], v17 offset:22528
    s_waitcnt vmcnt(11) lgkmcnt(12)
    v_mfma_f32_32x32x16_bf16 v[64:79], v[32:35], v[144:147], v[64:79]
    s_add_u32 s46, s42, 12288
    buffer_load_dwordx4 v[176:179], v2, s[12:15], s46 offen offset:0
    ds_read_b64_tr_b16 v[60:61], v18 offset:20480
    ds_read_b64_tr_b16 v[62:63], v18 offset:22528
    s_waitcnt lgkmcnt(12)
    v_mfma_f32_32x32x16_bf16 v[80:95], v[36:39], v[144:147], v[80:95]
    ds_read_b64_tr_b16 v[32:33], v15 offset:24576
    ds_read_b64_tr_b16 v[34:35], v15 offset:26624
    s_waitcnt lgkmcnt(12)
    v_mfma_f32_32x32x16_bf16 v[96:111], v[40:43], v[144:147], v[96:111]
    buffer_load_dwordx4 v[180:183], v2, s[12:15], s46 offen offset:1024
    ds_read_b64_tr_b16 v[36:37], v16 offset:24576
    ds_read_b64_tr_b16 v[38:39], v16 offset:26624
    s_waitcnt lgkmcnt(12)
    v_mfma_f32_32x32x16_bf16 v[112:127], v[44:47], v[144:147], v[112:127]
    ds_read_b64_tr_b16 v[40:41], v17 offset:24576
    ds_read_b64_tr_b16 v[42:43], v17 offset:26624
    s_waitcnt vmcnt(12) lgkmcnt(12)
    v_mfma_f32_32x32x16_bf16 v[64:79], v[48:51], v[148:151], v[64:79]
    buffer_load_dwordx4 v[184:187], v2, s[12:15], s46 offen offset:2048
    ds_read_b64_tr_b16 v[44:45], v18 offset:24576
    ds_read_b64_tr_b16 v[46:47], v18 offset:26624
    s_waitcnt lgkmcnt(12)
    v_mfma_f32_32x32x16_bf16 v[80:95], v[52:55], v[148:151], v[80:95]
    ds_read_b64_tr_b16 v[48:49], v15 offset:28672
    ds_read_b64_tr_b16 v[50:51], v15 offset:30720
    s_waitcnt lgkmcnt(12)
    v_mfma_f32_32x32x16_bf16 v[96:111], v[56:59], v[148:151], v[96:111]
    buffer_load_dwordx4 v[188:191], v2, s[12:15], s46 offen offset:3072
    ds_read_b64_tr_b16 v[52:53], v16 offset:28672
    ds_read_b64_tr_b16 v[54:55], v16 offset:30720
    s_waitcnt lgkmcnt(12)
    v_mfma_f32_32x32x16_bf16 v[112:127], v[60:63], v[148:151], v[112:127]
    ds_read_b64_tr_b16 v[56:57], v17 offset:28672
    ds_read_b64_tr_b16 v[58:59], v17 offset:30720
    s_waitcnt vmcnt(13) lgkmcnt(12)
    v_mfma_f32_32x32x16_bf16 v[64:79], v[32:35], v[152:155], v[64:79]
    ds_read_b64_tr_b16 v[60:61], v18 offset:28672
    ds_read_b64_tr_b16 v[62:63], v18 offset:30720
    s_waitcnt lgkmcnt(12)
    v_mfma_f32_32x32x16_bf16 v[80:95], v[36:39], v[152:155], v[80:95]
    ds_read_b64_tr_b16 v[32:33], v15 offset:32768
    ds_read_b64_tr_b16 v[34:35], v15 offset:34816
    s_waitcnt lgkmcnt(12)
    v_mfma_f32_32x32x16_bf16 v[96:111], v[40:43], v[152:155], v[96:111]
    ds_read_b64_tr_b16 v[36:37], v16 offset:32768
    ds_read_b64_tr_b16 v[38:39], v16 offset:34816
    s_waitcnt lgkmcnt(12)
    v_mfma_f32_32x32x16_bf16 v[112:127], v[44:47], v[152:155], v[112:127]
    ds_read_b64_tr_b16 v[40:41], v17 offset:32768
    ds_read_b64_tr_b16 v[42:43], v17 offset:34816
    s_waitcnt vmcnt(12) lgkmcnt(12)
    v_mfma_f32_32x32x16_bf16 v[64:79], v[48:51], v[156:159], v[64:79]
    ds_read_b64_tr_b16 v[44:45], v18 offset:32768
    ds_read_b64_tr_b16 v[46:47], v18 offset:34816
    s_waitcnt lgkmcnt(12)
    v_mfma_f32_32x32x16_bf16 v[80:95], v[52:55], v[156:159], v[80:95]
    ds_read_b64_tr_b16 v[48:49], v15 offset:36864
    ds_read_b64_tr_b16 v[50:51], v15 offset:38912
    s_waitcnt lgkmcnt(12)
    v_mfma_f32_32x32x16_bf16 v[96:111], v[56:59], v[156:159], v[96:111]
    ds_read_b64_tr_b16 v[52:53], v16 offset:36864
    ds_read_b64_tr_b16 v[54:55], v16 offset:38912
    s_waitcnt lgkmcnt(12)
    v_mfma_f32_32x32x16_bf16 v[112:127], v[60:63], v[156:159], v[112:127]
    s_waitcnt vmcnt(8)
    s_barrier
    ds_read_b64_tr_b16 v[56:57], v17 offset:36864
    ds_read_b64_tr_b16 v[58:59], v17 offset:38912
    s_waitcnt vmcnt(7) lgkmcnt(12)
    v_mfma_f32_32x32x16_bf16 v[64:79], v[32:35], v[160:163], v[64:79]
    s_add_u32 m0, s41, 98304
    s_add_u32 s45, s32, 3145728
    buffer_load_dwordx4 v5, s[8:11], s45 offen lds
    ds_read_b64_tr_b16 v[60:61], v18 offset:36864
    ds_read_b64_tr_b16 v[62:63], v18 offset:38912
    s_waitcnt lgkmcnt(12)
    v_mfma_f32_32x32x16_bf16 v[80:95], v[36:39], v[160:163], v[80:95]
    buffer_load_dwordx4 v6, s[8:11], s45 offen offset:1024 lds
    ds_read_b64_tr_b16 v[32:33], v15 offset:40960
    ds_read_b64_tr_b16 v[34:35], v15 offset:43008
    s_waitcnt lgkmcnt(12)
    v_mfma_f32_32x32x16_bf16 v[96:111], v[40:43], v[160:163], v[96:111]
    ds_read_b64_tr_b16 v[36:37], v16 offset:40960
    ds_read_b64_tr_b16 v[38:39], v16 offset:43008
    s_waitcnt lgkmcnt(12)
    v_mfma_f32_32x32x16_bf16 v[112:127], v[44:47], v[160:163], v[112:127]
    s_add_u32 m0, s41, 114688
    s_add_u32 s45, s32, 3670016
    buffer_load_dwordx4 v5, s[8:11], s45 offen lds
    ds_read_b64_tr_b16 v[40:41], v17 offset:40960
    ds_read_b64_tr_b16 v[42:43], v17 offset:43008
    s_waitcnt vmcnt(9) lgkmcnt(12)
    v_mfma_f32_32x32x16_bf16 v[64:79], v[48:51], v[164:167], v[64:79]
    buffer_load_dwordx4 v6, s[8:11], s45 offen offset:1024 lds
    ds_read_b64_tr_b16 v[44:45], v18 offset:40960
    ds_read_b64_tr_b16 v[46:47], v18 offset:43008
    s_waitcnt lgkmcnt(12)
    v_mfma_f32_32x32x16_bf16 v[80:95], v[52:55], v[164:167], v[80:95]
    ds_read_b64_tr_b16 v[48:49], v15 offset:45056
    ds_read_b64_tr_b16 v[50:51], v15 offset:47104
    s_waitcnt lgkmcnt(12)
    v_mfma_f32_32x32x16_bf16 v[96:111], v[56:59], v[164:167], v[96:111]
    s_add_u32 s46, s42, 16384
    buffer_load_dwordx4 v[192:195], v2, s[12:15], s46 offen offset:0
    ds_read_b64_tr_b16 v[52:53], v16 offset:45056
    ds_read_b64_tr_b16 v[54:55], v16 offset:47104
    s_waitcnt lgkmcnt(12)
    v_mfma_f32_32x32x16_bf16 v[112:127], v[60:63], v[164:167], v[112:127]
    buffer_load_dwordx4 v[196:199], v2, s[12:15], s46 offen offset:1024
    ds_read_b64_tr_b16 v[56:57], v17 offset:45056
    ds_read_b64_tr_b16 v[58:59], v17 offset:47104
    s_waitcnt vmcnt(11) lgkmcnt(12)
    v_mfma_f32_32x32x16_bf16 v[64:79], v[32:35], v[168:171], v[64:79]
    ds_read_b64_tr_b16 v[60:61], v18 offset:45056
    ds_read_b64_tr_b16 v[62:63], v18 offset:47104
    s_waitcnt lgkmcnt(12)
    v_mfma_f32_32x32x16_bf16 v[80:95], v[36:39], v[168:171], v[80:95]
    buffer_load_dwordx4 v[200:203], v2, s[12:15], s46 offen offset:2048
    ds_read_b64_tr_b16 v[32:33], v15 offset:49152
    ds_read_b64_tr_b16 v[34:35], v15 offset:51200
    s_waitcnt lgkmcnt(12)
    v_mfma_f32_32x32x16_bf16 v[96:111], v[40:43], v[168:171], v[96:111]
    buffer_load_dwordx4 v[204:207], v2, s[12:15], s46 offen offset:3072
    ds_read_b64_tr_b16 v[36:37], v16 offset:49152
    ds_read_b64_tr_b16 v[38:39], v16 offset:51200
    s_waitcnt lgkmcnt(12)
    v_mfma_f32_32x32x16_bf16 v[112:127], v[44:47], v[168:171], v[112:127]
    ds_read_b64_tr_b16 v[40:41], v17 offset:49152
    ds_read_b64_tr_b16 v[42:43], v17 offset:51200
    s_waitcnt vmcnt(12) lgkmcnt(12)
    v_mfma_f32_32x32x16_bf16 v[64:79], v[48:51], v[172:175], v[64:79]
    s_add_u32 s46, s42, 20480
    buffer_load_dwordx4 v[208:211], v2, s[12:15], s46 offen offset:0
    ds_read_b64_tr_b16 v[44:45], v18 offset:49152
    ds_read_b64_tr_b16 v[46:47], v18 offset:51200
    s_waitcnt lgkmcnt(12)
    v_mfma_f32_32x32x16_bf16 v[80:95], v[52:55], v[172:175], v[80:95]
    buffer_load_dwordx4 v[212:215], v2, s[12:15], s46 offen offset:1024
    ds_read_b64_tr_b16 v[48:49], v15 offset:53248
    ds_read_b64_tr_b16 v[50:51], v15 offset:55296
    s_waitcnt lgkmcnt(12)
    v_mfma_f32_32x32x16_bf16 v[96:111], v[56:59], v[172:175], v[96:111]
    ds_read_b64_tr_b16 v[52:53], v16 offset:53248
    ds_read_b64_tr_b16 v[54:55], v16 offset:55296
    s_waitcnt lgkmcnt(12)
    v_mfma_f32_32x32x16_bf16 v[112:127], v[60:63], v[172:175], v[112:127]
    buffer_load_dwordx4 v[216:219], v2, s[12:15], s46 offen offset:2048
    ds_read_b64_tr_b16 v[56:57], v17 offset:53248
    ds_read_b64_tr_b16 v[58:59], v17 offset:55296
    s_waitcnt vmcnt(14) lgkmcnt(12)
    v_mfma_f32_32x32x16_bf16 v[64:79], v[32:35], v[176:179], v[64:79]
    buffer_load_dwordx4 v[220:223], v2, s[12:15], s46 offen offset:3072
    ds_read_b64_tr_b16 v[60:61], v18 offset:53248
    ds_read_b64_tr_b16 v[62:63], v18 offset:55296
    s_waitcnt lgkmcnt(12)
    v_mfma_f32_32x32x16_bf16 v[80:95], v[36:39], v[176:179], v[80:95]
    ds_read_b64_tr_b16 v[32:33], v15 offset:57344
    ds_read_b64_tr_b16 v[34:35], v15 offset:59392
    s_waitcnt lgkmcnt(12)
    v_mfma_f32_32x32x16_bf16 v[96:111], v[40:43], v[176:179], v[96:111]
    s_cmp_lt_u32 s33, s43
    s_cselect_b32 s37, s33, s44
    s_mov_b32 m0, s35
    s_add_u32 s33, s33, 16384
    buffer_load_dwordx4 v7, s[20:23], s37 offen lds
    ds_read_b64_tr_b16 v[36:37], v16 offset:57344
    ds_read_b64_tr_b16 v[38:39], v16 offset:59392
    s_waitcnt lgkmcnt(12)
    v_mfma_f32_32x32x16_bf16 v[112:127], v[44:47], v[176:179], v[112:127]
    buffer_load_dwordx4 v8, s[20:23], s37 offen offset:1024 lds
    s_add_u32 s35, s35, 32768
    s_and_b32 s35, s35, 0x1ffff
    ds_read_b64_tr_b16 v[40:41], v17 offset:57344
    ds_read_b64_tr_b16 v[42:43], v17 offset:59392
    s_waitcnt vmcnt(16) lgkmcnt(12)
    v_mfma_f32_32x32x16_bf16 v[64:79], v[48:51], v[180:183], v[64:79]
    ds_read_b64_tr_b16 v[44:45], v18 offset:57344
    ds_read_b64_tr_b16 v[46:47], v18 offset:59392
    s_waitcnt lgkmcnt(12)
    v_mfma_f32_32x32x16_bf16 v[80:95], v[52:55], v[180:183], v[80:95]
    s_cmp_lt_u32 s34, s43
    s_cselect_b32 s37, s34, s44
    s_mov_b32 m0, s36
    s_add_u32 s34, s34, 16384
    buffer_load_dwordx4 v9, s[24:27], s37 offen lds
    ds_read_b64_tr_b16 v[48:49], v15 offset:61440
    ds_read_b64_tr_b16 v[50:51], v15 offset:63488
    s_waitcnt lgkmcnt(12)
    v_mfma_f32_32x32x16_bf16 v[96:111], v[56:59], v[180:183], v[96:111]
    buffer_load_dwordx4 v9, s[24:27], s37 offen offset:1024 lds
    s_add_u32 s36, s36, 32768
    s_and_b32 s36, s36, 0x1ffff
    ds_read_b64_tr_b16 v[52:53], v16 offset:61440
    ds_read_b64_tr_b16 v[54:55], v16 offset:63488
    s_waitcnt lgkmcnt(12)
    v_mfma_f32_32x32x16_bf16 v[112:127], v[60:63], v[180:183], v[112:127]
    ds_read_b64_tr_b16 v[56:57], v17 offset:61440
    ds_read_b64_tr_b16 v[58:59], v17 offset:63488
    s_waitcnt vmcnt(17) lgkmcnt(12)
    v_mfma_f32_32x32x16_bf16 v[64:79], v[32:35], v[184:187], v[64:79]
    ds_read_b64_tr_b16 v[60:61], v18 offset:61440
    ds_read_b64_tr_b16 v[62:63], v18 offset:63488
    s_waitcnt lgkmcnt(12)
    v_mfma_f32_32x32x16_bf16 v[80:95], v[36:39], v[184:187], v[80:95]
    ds_read_b64_tr_b16 v[32:33], v19 offset:0
    ds_read_b64_tr_b16 v[34:35], v19 offset:2048
    s_waitcnt lgkmcnt(12)
    v_mfma_f32_32x32x16_bf16 v[96:111], v[40:43], v[184:187], v[96:111]
    ds_read_b64_tr_b16 v[36:37], v20 offset:0
    ds_read_b64_tr_b16 v[38:39], v20 offset:2048
    s_waitcnt lgkmcnt(12)
    v_mfma_f32_32x32x16_bf16 v[112:127], v[44:47], v[184:187], v[112:127]
    ds_read_b64_tr_b16 v[40:41], v21 offset:0
    ds_read_b64_tr_b16 v[42:43], v21 offset:2048
    s_waitcnt vmcnt(16) lgkmcnt(12)
    v_mfma_f32_32x32x16_bf16 v[64:79], v[48:51], v[188:191], v[64:79]
    ds_read_b64_tr_b16 v[44:45], v22 offset:0
    ds_read_b64_tr_b16 v[46:47], v22 offset:2048
    s_waitcnt lgkmcnt(12)
    v_mfma_f32_32x32x16_bf16 v[80:95], v[52:55], v[188:191], v[80:95]
    ds_read_b64_tr_b16 v[48:49], v19 offset:4096
    ds_read_b64_tr_b16 v[50:51], v19 offset:6144
    s_waitcnt lgkmcnt(12)
    v_mfma_f32_32x32x16_bf16 v[96:111], v[56:59], v[188:191], v[96:111]
    ds_read_b64_tr_b16 v[52:53], v20 offset:4096
    ds_read_b64_tr_b16 v[54:55], v20 offset:6144
    s_waitcnt lgkmcnt(12)
    v_mfma_f32_32x32x16_bf16 v[112:127], v[60:63], v[188:191], v[112:127]
    s_waitcnt vmcnt(12)
    s_barrier
    ds_read_b64_tr_b16 v[56:57], v21 offset:4096
    ds_read_b64_tr_b16 v[58:59], v21 offset:6144
    s_waitcnt vmcnt(11) lgkmcnt(12)
    v_mfma_f32_32x32x16_bf16 v[64:79], v[32:35], v[192:195], v[64:79]
    s_add_u32 s46, s42, 24576
    buffer_load_dwordx4 v[224:227], v2, s[12:15], s46 offen offset:0
    ds_read_b64_tr_b16 v[60:61], v22 offset:4096
    ds_read_b64_tr_b16 v[62:63], v22 offset:6144
    s_waitcnt lgkmcnt(12)
    v_mfma_f32_32x32x16_bf16 v[80:95], v[36:39], v[192:195], v[80:95]
    ds_read_b64_tr_b16 v[32:33], v19 offset:8192
    ds_read_b64_tr_b16 v[34:35], v19 offset:10240
    s_waitcnt lgkmcnt(12)
    v_mfma_f32_32x32x16_bf16 v[96:111], v[40:43], v[192:195], v[96:111]
    buffer_load_dwordx4 v[228:231], v2, s[12:15], s46 offen offset:1024
    ds_read_b64_tr_b16 v[36:37], v20 offset:8192
    ds_read_b64_tr_b16 v[38:39], v20 offset:10240
    s_waitcnt lgkmcnt(12)
    v_mfma_f32_32x32x16_bf16 v[112:127], v[44:47], v[192:195], v[112:127]
    ds_read_b64_tr_b16 v[40:41], v21 offset:8192
    ds_read_b64_tr_b16 v[42:43], v21 offset:10240
    s_waitcnt vmcnt(12) lgkmcnt(12)
    v_mfma_f32_32x32x16_bf16 v[64:79], v[48:51], v[196:199], v[64:79]
    buffer_load_dwordx4 v[232:235], v2, s[12:15], s46 offen offset:2048
    ds_read_b64_tr_b16 v[44:45], v22 offset:8192
    ds_read_b64_tr_b16 v[46:47], v22 offset:10240
    s_waitcnt lgkmcnt(12)
    v_mfma_f32_32x32x16_bf16 v[80:95], v[52:55], v[196:199], v[80:95]
    ds_read_b64_tr_b16 v[48:49], v19 offset:12288
    ds_read_b64_tr_b16 v[50:51], v19 offset:14336
    s_waitcnt lgkmcnt(12)
    v_mfma_f32_32x32x16_bf16 v[96:111], v[56:59], v[196:199], v[96:111]
    buffer_load_dwordx4 v[236:239], v2, s[12:15], s46 offen offset:3072
    ds_read_b64_tr_b16 v[52:53], v20 offset:12288
    ds_read_b64_tr_b16 v[54:55], v20 offset:14336
    s_waitcnt lgkmcnt(12)
    v_mfma_f32_32x32x16_bf16 v[112:127], v[60:63], v[196:199], v[112:127]
    ds_read_b64_tr_b16 v[56:57], v21 offset:12288
    ds_read_b64_tr_b16 v[58:59], v21 offset:14336
    s_waitcnt vmcnt(13) lgkmcnt(12)
    v_mfma_f32_32x32x16_bf16 v[64:79], v[32:35], v[200:203], v[64:79]
    s_add_u32 s46, s42, 28672
    buffer_load_dwordx4 v[240:243], v2, s[12:15], s46 offen offset:0
    ds_read_b64_tr_b16 v[60:61], v22 offset:12288
    ds_read_b64_tr_b16 v[62:63], v22 offset:14336
    s_waitcnt lgkmcnt(12)
    v_mfma_f32_32x32x16_bf16 v[80:95], v[36:39], v[200:203], v[80:95]
    ds_read_b64_tr_b16 v[32:33], v19 offset:16384
    ds_read_b64_tr_b16 v[34:35], v19 offset:18432
    s_waitcnt lgkmcnt(12)
    v_mfma_f32_32x32x16_bf16 v[96:111], v[40:43], v[200:203], v[96:111]
    buffer_load_dwordx4 v[244:247], v2, s[12:15], s46 offen offset:1024
    ds_read_b64_tr_b16 v[36:37], v20 offset:16384
    ds_read_b64_tr_b16 v[38:39], v20 offset:18432
    s_waitcnt lgkmcnt(12)
    v_mfma_f32_32x32x16_bf16 v[112:127], v[44:47], v[200:203], v[112:127]
    ds_read_b64_tr_b16 v[40:41], v21 offset:16384
    ds_read_b64_tr_b16 v[42:43], v21 offset:18432
    s_waitcnt vmcnt(14) lgkmcnt(12)
    v_mfma_f32_32x32x16_bf16 v[64:79], v[48:51], v[204:207], v[64:79]
    buffer_load_dwordx4 v[248:251], v2, s[12:15], s46 offen offset:2048
    ds_read_b64_tr_b16 v[44:45], v22 offset:16384
    ds_read_b64_tr_b16 v[46:47], v22 offset:18432
    s_waitcnt lgkmcnt(12)
    v_mfma_f32_32x32x16_bf16 v[80:95], v[52:55], v[204:207], v[80:95]
    ds_read_b64_tr_b16 v[48:49], v19 offset:20480
    ds_read_b64_tr_b16 v[50:51], v19 offset:22528
    s_waitcnt lgkmcnt(12)
    v_mfma_f32_32x32x16_bf16 v[96:111], v[56:59], v[204:207], v[96:111]
    buffer_load_dwordx4 v[252:255], v2, s[12:15], s46 offen offset:3072
    ds_read_b64_tr_b16 v[52:53], v20 offset:20480
    ds_read_b64_tr_b16 v[54:55], v20 offset:22528
    s_waitcnt lgkmcnt(12)
    v_mfma_f32_32x32x16_bf16 v[112:127], v[60:63], v[204:207], v[112:127]
    ds_read_b64_tr_b16 v[56:57], v21 offset:20480
    ds_read_b64_tr_b16 v[58:59], v21 offset:22528
    s_waitcnt vmcnt(15) lgkmcnt(12)
    v_mfma_f32_32x32x16_bf16 v[64:79], v[32:35], v[208:211], v[64:79]
    s_cmp_lt_u32 s33, s43
    s_cselect_b32 s37, s33, s44
    s_mov_b32 m0, s35
    s_add_u32 s33, s33, 16384
    buffer_load_dwordx4 v7, s[20:23], s37 offen lds
    ds_read_b64_tr_b16 v[60:61], v22 offset:20480
    ds_read_b64_tr_b16 v[62:63], v22 offset:22528
    s_waitcnt lgkmcnt(12)
    v_mfma_f32_32x32x16_bf16 v[80:95], v[36:39], v[208:211], v[80:95]
    ds_read_b64_tr_b16 v[32:33], v19 offset:24576
    ds_read_b64_tr_b16 v[34:35], v19 offset:26624
    s_waitcnt lgkmcnt(12)
    v_mfma_f32_32x32x16_bf16 v[96:111], v[40:43], v[208:211], v[96:111]
    buffer_load_dwordx4 v8, s[20:23], s37 offen offset:1024 lds
    s_add_u32 s35, s35, 32768
    s_and_b32 s35, s35, 0x1ffff
    ds_read_b64_tr_b16 v[36:37], v20 offset:24576
    ds_read_b64_tr_b16 v[38:39], v20 offset:26624
    s_waitcnt lgkmcnt(12)
    v_mfma_f32_32x32x16_bf16 v[112:127], v[44:47], v[208:211], v[112:127]
    ds_read_b64_tr_b16 v[40:41], v21 offset:24576
    ds_read_b64_tr_b16 v[42:43], v21 offset:26624
    s_waitcnt vmcnt(16) lgkmcnt(12)
    v_mfma_f32_32x32x16_bf16 v[64:79], v[48:51], v[212:215], v[64:79]
    s_cmp_lt_u32 s34, s43
    s_cselect_b32 s37, s34, s44
    s_mov_b32 m0, s36
    s_add_u32 s34, s34, 16384
    buffer_load_dwordx4 v9, s[24:27], s37 offen lds
    ds_read_b64_tr_b16 v[44:45], v22 offset:24576
    ds_read_b64_tr_b16 v[46:47], v22 offset:26624
    s_waitcnt lgkmcnt(12)
    v_mfma_f32_32x32x16_bf16 v[80:95], v[52:55], v[212:215], v[80:95]
    ds_read_b64_tr_b16 v[48:49], v19 offset:28672
    ds_read_b64_tr_b16 v[50:51], v19 offset:30720
    s_waitcnt lgkmcnt(12)
    v_mfma_f32_32x32x16_bf16 v[96:111], v[56:59], v[212:215], v[96:111]
    buffer_load_dwordx4 v9, s[24:27], s37 offen offset:1024 lds
    s_add_u32 s36, s36, 32768
    s_and_b32 s36, s36, 0x1ffff
    ds_read_b64_tr_b16 v[52:53], v20 offset:28672
    ds_read_b64_tr_b16 v[54:55], v20 offset:30720
    s_waitcnt lgkmcnt(12)
    v_mfma_f32_32x32x16_bf16 v[112:127], v[60:63], v[212:215], v[112:127]
    ds_read_b64_tr_b16 v[56:57], v21 offset:28672
    ds_read_b64_tr_b16 v[58:59], v21 offset:30720
    s_waitcnt vmcnt(17) lgkmcnt(12)
    v_mfma_f32_32x32x16_bf16 v[64:79], v[32:35], v[216:219], v[64:79]
    ds_read_b64_tr_b16 v[60:61], v22 offset:28672
    ds_read_b64_tr_b16 v[62:63], v22 offset:30720
    s_waitcnt lgkmcnt(12)
    v_mfma_f32_32x32x16_bf16 v[80:95], v[36:39], v[216:219], v[80:95]
    ds_read_b64_tr_b16 v[32:33], v19 offset:32768
    ds_read_b64_tr_b16 v[34:35], v19 offset:34816
    s_waitcnt lgkmcnt(12)
    v_mfma_f32_32x32x16_bf16 v[96:111], v[40:43], v[216:219], v[96:111]
    ds_read_b64_tr_b16 v[36:37], v20 offset:32768
    ds_read_b64_tr_b16 v[38:39], v20 offset:34816
    s_waitcnt lgkmcnt(12)
    v_mfma_f32_32x32x16_bf16 v[112:127], v[44:47], v[216:219], v[112:127]
    ds_read_b64_tr_b16 v[40:41], v21 offset:32768
    ds_read_b64_tr_b16 v[42:43], v21 offset:34816
    s_waitcnt vmcnt(16) lgkmcnt(12)
    v_mfma_f32_32x32x16_bf16 v[64:79], v[48:51], v[220:223], v[64:79]
    ds_read_b64_tr_b16 v[44:45], v22 offset:32768
    ds_read_b64_tr_b16 v[46:47], v22 offset:34816
    s_waitcnt lgkmcnt(12)
    v_mfma_f32_32x32x16_bf16 v[80:95], v[52:55], v[220:223], v[80:95]
    ds_read_b64_tr_b16 v[48:49], v19 offset:36864
    ds_read_b64_tr_b16 v[50:51], v19 offset:38912
    s_waitcnt lgkmcnt(12)
    v_mfma_f32_32x32x16_bf16 v[96:111], v[56:59], v[220:223], v[96:111]
    ds_read_b64_tr_b16 v[52:53], v20 offset:36864
    ds_read_b64_tr_b16 v[54:55], v20 offset:38912
    s_waitcnt lgkmcnt(12)
    v_mfma_f32_32x32x16_bf16 v[112:127], v[60:63], v[220:223], v[112:127]
    s_barrier
    ds_read_b64_tr_b16 v[56:57], v21 offset:36864
    ds_read_b64_tr_b16 v[58:59], v21 offset:38912
    s_waitcnt vmcnt(11) lgkmcnt(12)
    v_mfma_f32_32x32x16_bf16 v[64:79], v[32:35], v[224:227], v[64:79]
    s_cmp_lt_u32 s33, s43
    s_cselect_b32 s37, s33, s44
    s_mov_b32 m0, s35
    s_add_u32 s33, s33, 16384
    buffer_load_dwordx4 v7, s[20:23], s37 offen lds
    ds_read_b64_tr_b16 v[60:61], v22 offset:36864
    ds_read_b64_tr_b16 v[62:63], v22 offset:38912
    s_waitcnt lgkmcnt(12)
    v_mfma_f32_32x32x16_bf16 v[80:95], v[36:39], v[224:227], v[80:95]
    ds_read_b64_tr_b16 v[32:33], v19 offset:40960
    ds_read_b64_tr_b16 v[34:35], v19 offset:43008
    s_waitcnt lgkmcnt(12)
    v_mfma_f32_32x32x16_bf16 v[96:111], v[40:43], v[224:227], v[96:111]
    ds_read_b64_tr_b16 v[36:37], v20 offset:40960
    ds_read_b64_tr_b16 v[38:39], v20 offset:43008
    s_waitcnt lgkmcnt(12)
    v_mfma_f32_32x32x16_bf16 v[112:127], v[44:47], v[224:227], v[112:127]
    ds_read_b64_tr_b16 v[40:41], v21 offset:40960
    ds_read_b64_tr_b16 v[42:43], v21 offset:43008
    s_waitcnt vmcnt(11) lgkmcnt(12)
    v_mfma_f32_32x32x16_bf16 v[64:79], v[48:51], v[228:231], v[64:79]
    ds_read_b64_tr_b16 v[44:45], v22 offset:40960
    ds_read_b64_tr_b16 v[46:47], v22 offset:43008
    s_waitcnt lgkmcnt(12)
    v_mfma_f32_32x32x16_bf16 v[80:95], v[52:55], v[228:231], v[80:95]
    ds_read_b64_tr_b16 v[48:49], v19 offset:45056
    ds_read_b64_tr_b16 v[50:51], v19 offset:47104
    s_waitcnt lgkmcnt(12)
    v_mfma_f32_32x32x16_bf16 v[96:111], v[56:59], v[228:231], v[96:111]
    buffer_load_dwordx4 v8, s[20:23], s37 offen offset:1024 lds
    s_add_u32 s35, s35, 32768
    s_and_b32 s35, s35, 0x1ffff
    ds_read_b64_tr_b16 v[52:53], v20 offset:45056
    ds_read_b64_tr_b16 v[54:55], v20 offset:47104
    s_waitcnt lgkmcnt(12)
    v_mfma_f32_32x32x16_bf16 v[112:127], v[60:63], v[228:231], v[112:127]
    ds_read_b64_tr_b16 v[56:57], v21 offset:45056
    ds_read_b64_tr_b16 v[58:59], v21 offset:47104
    s_waitcnt vmcnt(11) lgkmcnt(12)
    v_mfma_f32_32x32x16_bf16 v[64:79], v[32:35], v[232:235], v[64:79]
    ds_read_b64_tr_b16 v[60:61], v22 offset:45056
    ds_read_b64_tr_b16 v[62:63], v22 offset:47104
    s_waitcnt lgkmcnt(12)
    v_mfma_f32_32x32x16_bf16 v[80:95], v[36:39], v[232:235], v[80:95]
    ds_read_b64_tr_b16 v[32:33], v19 offset:49152
    ds_read_b64_tr_b16 v[34:35], v19 offset:51200
    s_waitcnt lgkmcnt(12)
    v_mfma_f32_32x32x16_bf16 v[96:111], v[40:43], v[232:235], v[96:111]
    ds_read_b64_tr_b16 v[36:37], v20 offset:49152
    ds_read_b64_tr_b16 v[38:39], v20 offset:51200
    s_waitcnt lgkmcnt(12)
    v_mfma_f32_32x32x16_bf16 v[112:127], v[44:47], v[232:235], v[112:127]
    ds_read_b64_tr_b16 v[40:41], v21 offset:49152
    ds_read_b64_tr_b16 v[42:43], v21 offset:51200
    s_waitcnt vmcnt(10) lgkmcnt(12)
    v_mfma_f32_32x32x16_bf16 v[64:79], v[48:51], v[236:239], v[64:79]
    s_cmp_lt_u32 s34, s43
    s_cselect_b32 s37, s34, s44
    s_mov_b32 m0, s36
    s_add_u32 s34, s34, 16384
    buffer_load_dwordx4 v9, s[24:27], s37 offen lds
    ds_read_b64_tr_b16 v[44:45], v22 offset:49152
    ds_read_b64_tr_b16 v[46:47], v22 offset:51200
    s_waitcnt lgkmcnt(12)
    v_mfma_f32_32x32x16_bf16 v[80:95], v[52:55], v[236:239], v[80:95]
    ds_read_b64_tr_b16 v[48:49], v19 offset:53248
    ds_read_b64_tr_b16 v[50:51], v19 offset:55296
    s_waitcnt lgkmcnt(12)
    v_mfma_f32_32x32x16_bf16 v[96:111], v[56:59], v[236:239], v[96:111]
    ds_read_b64_tr_b16 v[52:53], v20 offset:53248
    ds_read_b64_tr_b16 v[54:55], v20 offset:55296
    s_waitcnt lgkmcnt(12)
    v_mfma_f32_32x32x16_bf16 v[112:127], v[60:63], v[236:239], v[112:127]
    ds_read_b64_tr_b16 v[56:57], v21 offset:53248
    ds_read_b64_tr_b16 v[58:59], v21 offset:55296
    s_waitcnt vmcnt(10) lgkmcnt(12)
    v_mfma_f32_32x32x16_bf16 v[64:79], v[32:35], v[240:243], v[64:79]
    ds_read_b64_tr_b16 v[60:61], v22 offset:53248
    ds_read_b64_tr_b16 v[62:63], v22 offset:55296
    s_waitcnt lgkmcnt(12)
    v_mfma_f32_32x32x16_bf16 v[80:95], v[36:39], v[240:243], v[80:95]
    ds_read_b64_tr_b16 v[32:33], v19 offset:57344
    ds_read_b64_tr_b16 v[34:35], v19 offset:59392
    s_waitcnt lgkmcnt(12)
    v_mfma_f32_32x32x16_bf16 v[96:111], v[40:43], v[240:243], v[96:111]
    buffer_load_dwordx4 v9, s[24:27], s37 offen offset:1024 lds
    s_add_u32 s36, s36, 32768
    s_and_b32 s36, s36, 0x1ffff
    ds_read_b64_tr_b16 v[36:37], v20 offset:57344
    ds_read_b64_tr_b16 v[38:39], v20 offset:59392
    s_waitcnt lgkmcnt(12)
    v_mfma_f32_32x32x16_bf16 v[112:127], v[44:47], v[240:243], v[112:127]
    ds_read_b64_tr_b16 v[40:41], v21 offset:57344
    ds_read_b64_tr_b16 v[42:43], v21 offset:59392
    s_waitcnt vmcnt(10) lgkmcnt(12)
    v_mfma_f32_32x32x16_bf16 v[64:79], v[48:51], v[244:247], v[64:79]
    ds_read_b64_tr_b16 v[44:45], v22 offset:57344
    ds_read_b64_tr_b16 v[46:47], v22 offset:59392
    s_waitcnt lgkmcnt(12)
    v_mfma_f32_32x32x16_bf16 v[80:95], v[52:55], v[244:247], v[80:95]
    ds_read_b64_tr_b16 v[48:49], v19 offset:61440
    ds_read_b64_tr_b16 v[50:51], v19 offset:63488
    s_waitcnt lgkmcnt(12)
    v_mfma_f32_32x32x16_bf16 v[96:111], v[56:59], v[244:247], v[96:111]
    ds_read_b64_tr_b16 v[52:53], v20 offset:61440
    ds_read_b64_tr_b16 v[54:55], v20 offset:63488
    s_waitcnt lgkmcnt(12)
    v_mfma_f32_32x32x16_bf16 v[112:127], v[60:63], v[244:247], v[112:127]
    ds_read_b64_tr_b16 v[56:57], v21 offset:61440
    ds_read_b64_tr_b16 v[58:59], v21 offset:63488
    s_waitcnt vmcnt(9) lgkmcnt(12)
    v_mfma_f32_32x32x16_bf16 v[64:79], v[32:35], v[248:251], v[64:79]
    ds_read_b64_tr_b16 v[60:61], v22 offset:61440
    ds_read_b64_tr_b16 v[62:63], v22 offset:63488
    s_waitcnt lgkmcnt(12)
    v_mfma_f32_32x32x16_bf16 v[80:95], v[36:39], v[248:251], v[80:95]
    s_waitcnt lgkmcnt(10)
    v_mfma_f32_32x32x16_bf16 v[96:111], v[40:43], v[248:251], v[96:111]
    s_waitcnt lgkmcnt(8)
    v_mfma_f32_32x32x16_bf16 v[112:127], v[44:47], v[248:251], v[112:127]
    s_waitcnt vmcnt(8) lgkmcnt(6)
    v_mfma_f32_32x32x16_bf16 v[64:79], v[48:51], v[252:255], v[64:79]
    s_waitcnt lgkmcnt(4)
    v_mfma_f32_32x32x16_bf16 v[80:95], v[52:55], v[252:255], v[80:95]
    s_waitcnt lgkmcnt(2)
    v_mfma_f32_32x32x16_bf16 v[96:111], v[56:59], v[252:255], v[96:111]
    s_waitcnt lgkmcnt(0)
    v_mfma_f32_32x32x16_bf16 v[112:127], v[60:63], v[252:255], v[112:127]
    s_waitcnt vmcnt(6)
    s_barrier
    v_and_b32 v3, 31, v1
    v_and_b32 v4, 15, v1
    v_lshrrev_b32 v19, 5, v1
    v_xor_b32 v19, v19, v4
    v_lshlrev_b32 v19, 4, v19
    v_lshl_add_u32 v19, v3, 8, v19
    v_xor_b32 v20, 32, v19
    v_xor_b32 v21, 64, v19
    v_xor_b32 v22, 96, v19
    v_xor_b32 v23, 128, v19
    v_xor_b32 v24, 160, v19
    v_xor_b32 v25, 192, v19
    v_xor_b32 v26, 224, v19
    v_mul_f32 v64, s39, v64
    v_mul_f32 v65, s39, v65
    v_mul_f32 v66, s39, v66
    v_mul_f32 v67, s39, v67
    v_mul_f32 v68, s39, v68
    v_mul_f32 v69, s39, v69
    v_mul_f32 v70, s39, v70
    v_mul_f32 v71, s39, v71
    v_mul_f32 v72, s39, v72
    v_mul_f32 v73, s39, v73
    v_mul_f32 v74, s39, v74
    v_mul_f32 v75, s39, v75
    v_mul_f32 v76, s39, v76
    v_mul_f32 v77, s39, v77
    v_mul_f32 v78, s39, v78
    v_mul_f32 v79, s39, v79
    v_cvt_pk_bf16_f32 v32, v64, v65
    v_cvt_pk_bf16_f32 v33, v66, v67
    v_cvt_pk_bf16_f32 v34, v68, v69
    v_cvt_pk_bf16_f32 v35, v70, v71
    v_cvt_pk_bf16_f32 v36, v72, v73
    v_cvt_pk_bf16_f32 v37, v74, v75
    v_cvt_pk_bf16_f32 v38, v76, v77
    v_cvt_pk_bf16_f32 v39, v78, v79
    v_mul_f32 v80, s39, v80
    v_mul_f32 v81, s39, v81
    v_mul_f32 v82, s39, v82
    v_mul_f32 v83, s39, v83
    v_mul_f32 v84, s39, v84
    v_mul_f32 v85, s39, v85
    v_mul_f32 v86, s39, v86
    v_mul_f32 v87, s39, v87
    v_mul_f32 v88, s39, v88
    v_mul_f32 v89, s39, v89
    v_mul_f32 v90, s39, v90
    v_mul_f32 v91, s39, v91
    v_mul_f32 v92, s39, v92
    v_mul_f32 v93, s39, v93
    v_mul_f32 v94, s39, v94
    v_mul_f32 v95, s39, v95
    v_cvt_pk_bf16_f32 v40, v80, v81
    v_cvt_pk_bf16_f32 v41, v82, v83
    v_cvt_pk_bf16_f32 v42, v84, v85
    v_cvt_pk_bf16_f32 v43, v86, v87
    v_cvt_pk_bf16_f32 v44, v88, v89
    v_cvt_pk_bf16_f32 v45, v90, v91
    v_cvt_pk_bf16_f32 v46, v92, v93
    v_cvt_pk_bf16_f32 v47, v94, v95
    v_mul_f32 v96, s39, v96
    v_mul_f32 v97, s39, v97
    v_mul_f32 v98, s39, v98
    v_mul_f32 v99, s39, v99
    v_mul_f32 v100, s39, v100
    v_mul_f32 v101, s39, v101
    v_mul_f32 v102, s39, v102
    v_mul_f32 v103, s39, v103
    v_mul_f32 v104, s39, v104
    v_mul_f32 v105, s39, v105
    v_mul_f32 v106, s39, v106
    v_mul_f32 v107, s39, v107
    v_mul_f32 v108, s39, v108
    v_mul_f32 v109, s39, v109
    v_mul_f32 v110, s39, v110
    v_mul_f32 v111, s39, v111
    v_cvt_pk_bf16_f32 v48, v96, v97
    v_cvt_pk_bf16_f32 v49, v98, v99
    v_cvt_pk_bf16_f32 v50, v100, v101
    v_cvt_pk_bf16_f32 v51, v102, v103
    v_cvt_pk_bf16_f32 v52, v104, v105
    v_cvt_pk_bf16_f32 v53, v106, v107
    v_cvt_pk_bf16_f32 v54, v108, v109
    v_cvt_pk_bf16_f32 v55, v110, v111
    v_mul_f32 v112, s39, v112
    v_mul_f32 v113, s39, v113
    v_mul_f32 v114, s39, v114
    v_mul_f32 v115, s39, v115
    v_mul_f32 v116, s39, v116
    v_mul_f32 v117, s39, v117
    v_mul_f32 v118, s39, v118
    v_mul_f32 v119, s39, v119
    v_mul_f32 v120, s39, v120
    v_mul_f32 v121, s39, v121
    v_mul_f32 v122, s39, v122
    v_mul_f32 v123, s39, v123
    v_mul_f32 v124, s39, v124
    v_mul_f32 v125, s39, v125
    v_mul_f32 v126, s39, v126
    v_mul_f32 v127, s39, v127
    v_cvt_pk_bf16_f32 v56, v112, v113
    v_cvt_pk_bf16_f32 v57, v114, v115
    v_cvt_pk_bf16_f32 v58, v116, v117
    v_cvt_pk_bf16_f32 v59, v118, v119
    v_cvt_pk_bf16_f32 v60, v120, v121
    v_cvt_pk_bf16_f32 v61, v122, v123
    v_cvt_pk_bf16_f32 v62, v124, v125
    v_cvt_pk_bf16_f32 v63, v126, v127
    v_permlane32_swap_b32 v32, v34
    v_permlane32_swap_b32 v33, v35
    v_permlane32_swap_b32 v36, v38
    v_permlane32_swap_b32 v37, v39
    v_permlane32_swap_b32 v40, v42
    v_permlane32_swap_b32 v41, v43
    v_permlane32_swap_b32 v44, v46
    v_permlane32_swap_b32 v45, v47
    v_permlane32_swap_b32 v48, v50
    v_permlane32_swap_b32 v49, v51
    v_permlane32_swap_b32 v52, v54
    v_permlane32_swap_b32 v53, v55
    v_permlane32_swap_b32 v56, v58
    v_permlane32_swap_b32 v57, v59
    v_permlane32_swap_b32 v60, v62
    v_permlane32_swap_b32 v61, v63
    ds_read_b128 v[80:83], v19 offset:0
    ds_read_b128 v[84:87], v20 offset:0
    ds_read_b128 v[88:91], v21 offset:0
    ds_read_b128 v[92:95], v22 offset:0
    ds_read_b128 v[96:99], v23 offset:0
    ds_read_b128 v[100:103], v24 offset:0
    ds_read_b128 v[104:107], v25 offset:0
    s_waitcnt lgkmcnt(6)
    v_mfma_f32_32x32x16_bf16 v[192:207], v[80:83], v[32:35], 0
    v_mov_b32 v128, 0
    v_mov_b32 v129, 0
    v_mov_b32 v130, 0
    v_mov_b32 v131, 0
    s_cmp_lt_u32 s33, s43
    s_cselect_b32 s37, s33, s44
    s_mov_b32 m0, s35
    s_add_u32 s33, s33, 16384
    buffer_load_dwordx4 v7, s[20:23], s37 offen lds
    ds_read_b128 v[108:111], v26 offset:0
    s_waitcnt lgkmcnt(6)
    v_mfma_f32_32x32x16_bf16 v[192:207], v[84:87], v[36:39], v[192:207]
    v_mov_b32 v132, 0
    v_mov_b32 v133, 0
    v_mov_b32 v134, 0
    v_mov_b32 v135, 0
    ds_read_b128 v[80:83], v19 offset:8192
    s_waitcnt lgkmcnt(6)
    v_mfma_f32_32x32x16_bf16 v[192:207], v[88:91], v[40:43], v[192:207]
    v_mov_b32 v136, 0
    v_mov_b32 v137, 0
    v_mov_b32 v138, 0
    v_mov_b32 v139, 0
    buffer_load_dwordx4 v8, s[20:23], s37 offen offset:1024 lds
    s_add_u32 s35, s35, 32768
    s_and_b32 s35, s35, 0x1ffff
    ds_read_b128 v[84:87], v20 offset:8192
    s_waitcnt lgkmcnt(6)
    v_mfma_f32_32x32x16_bf16 v[192:207], v[92:95], v[44:47], v[192:207]
    v_mov_b32 v140, 0
    v_mov_b32 v141, 0
    v_mov_b32 v142, 0
    v_mov_b32 v143, 0
    ds_read_b128 v[88:91], v21 offset:8192
    s_waitcnt lgkmcnt(6)
    v_mfma_f32_32x32x16_bf16 v[192:207], v[96:99], v[48:51], v[192:207]
    v_mov_b32 v144, 0
    v_mov_b32 v145, 0
    v_mov_b32 v146, 0
    v_mov_b32 v147, 0
    ds_read_b128 v[92:95], v22 offset:8192
    s_waitcnt lgkmcnt(6)
    v_mfma_f32_32x32x16_bf16 v[192:207], v[100:103], v[52:55], v[192:207]
    v_mov_b32 v148, 0
    v_mov_b32 v149, 0
    v_mov_b32 v150, 0
    v_mov_b32 v151, 0
    ds_read_b128 v[96:99], v23 offset:8192
    s_waitcnt lgkmcnt(6)
    v_mfma_f32_32x32x16_bf16 v[192:207], v[104:107], v[56:59], v[192:207]
    v_mov_b32 v152, 0
    v_mov_b32 v153, 0
    v_mov_b32 v154, 0
    v_mov_b32 v155, 0
    s_mov_b32 m0, s47
    s_nop 0
    buffer_load_dwordx4 v2, s[52:55], s61 offen lds
    ds_read_b128 v[100:103], v24 offset:8192
    s_waitcnt lgkmcnt(6)
    v_mfma_f32_32x32x16_bf16 v[192:207], v[108:111], v[60:63], v[192:207]
    v_mov_b32 v156, 0
    v_mov_b32 v157, 0
    v_mov_b32 v158, 0
    v_mov_b32 v159, 0
    buffer_load_dwordx4 v2, s[56:59], s61 offen lds
    s_add_u32 s61, s61, 1024
    ds_read_b128 v[104:107], v25 offset:8192
    s_waitcnt lgkmcnt(6)
    v_mfma_f32_32x32x16_bf16 v[208:223], v[80:83], v[32:35], 0
    v_mov_b32 v160, 0
    v_mov_b32 v161, 0
    v_mov_b32 v162, 0
    v_mov_b32 v163, 0
    ds_read_b128 v[108:111], v26 offset:8192
    s_waitcnt lgkmcnt(6)
    v_mfma_f32_32x32x16_bf16 v[208:223], v[84:87], v[36:39], v[208:223]
    v_mov_b32 v164, 0
    v_mov_b32 v165, 0
    v_mov_b32 v166, 0
    v_mov_b32 v167, 0
    ds_read_b128 v[80:83], v19 offset:32768
    s_waitcnt lgkmcnt(6)
    v_mfma_f32_32x32x16_bf16 v[208:223], v[88:91], v[40:43], v[208:223]
    v_mov_b32 v168, 0
    v_mov_b32 v169, 0
    v_mov_b32 v170, 0
    v_mov_b32 v171, 0
    s_lshr_b32 s62, s2, 4
    s_mul_i32 s45, s62, 37
    s_lshr_b32 s45, s45, 8
    s_mul_i32 s46, s45, 7
    s_sub_u32 s62, s62, s46
    s_bfe_u32 s46, s2, 0x10002
    s_mul_i32 s46, s46, 7
    s_add_u32 s62, s62, s46
    s_and_b32 s46, s2, 3
    s_lshl1_add_u32 s45, s46, s45
    s_lshl_b32 s62, s62, 8
    s_mul_i32 s46, s3, 28672
    s_add_u32 s62, s62, s46
    s_lshr_b32 s46, s3, 2
    s_lshl1_add_u32 s63, s45, s46
    s_lshl_b32 s63, s63, 17
    s_and_b32 s46, s3, 3
    s_lshl_b32 s46, s46, 10
    s_add_u32 s63, s63, s46
    s_add_u32 s63, s63, 2097152
    s_and_b32 s46, s2, 0xf8
    s_cmp_lt_u32 s46, 224
    s_cselect_b32 s46, s2, 0
    s_bitcmp1_b32 s46, 3
    s_cselect_b32 s62, s62, 0x40000000
    s_cselect_b32 s63, s63, 0x40000000
    s_mov_b32 s46, 3584
    s_lshl_b32 s45, s3, 10
    ds_read_b128 v[84:87], v20 offset:32768
    s_waitcnt lgkmcnt(6)
    v_mfma_f32_32x32x16_bf16 v[208:223], v[92:95], v[44:47], v[208:223]
    v_mov_b32 v172, 0
    v_mov_b32 v173, 0
    v_mov_b32 v174, 0
    v_mov_b32 v175, 0
    ds_read_b128 v[88:91], v21 offset:32768
    s_waitcnt lgkmcnt(6)
    v_mfma_f32_32x32x16_bf16 v[208:223], v[96:99], v[48:51], v[208:223]
    v_mov_b32 v176, 0
    v_mov_b32 v177, 0
    v_mov_b32 v178, 0
    v_mov_b32 v179, 0
    v_lshrrev_b32 v3, 4, v1
    v_and_b32 v6, 15, v1
    v_lshlrev_b32 v5, 2, v3
    v_xor_b32 v5, v5, v6
    v_lshlrev_b32 v5, 4, v5
    v_mad_u32_u24 v5, v3, s46, v5
    v_add_u32 v6, 13312, v5
    ds_read_b128 v[92:95], v22 offset:32768
    s_waitcnt lgkmcnt(6)
    v_mfma_f32_32x32x16_bf16 v[208:223], v[100:103], v[52:55], v[208:223]
    v_mov_b32 v180, 0
    v_mov_b32 v181, 0
    v_mov_b32 v182, 0
    v_mov_b32 v183, 0
    ds_read_b128 v[96:99], v23 offset:32768
    s_waitcnt lgkmcnt(6)
    v_mfma_f32_32x32x16_bf16 v[208:223], v[104:107], v[56:59], v[208:223]
    v_mov_b32 v184, 0
    v_mov_b32 v185, 0
    v_mov_b32 v186, 0
    v_mov_b32 v187, 0
    ds_read_b128 v[100:103], v24 offset:32768
    s_waitcnt lgkmcnt(6)
    v_mfma_f32_32x32x16_bf16 v[208:223], v[108:111], v[60:63], v[208:223]
    v_mov_b32 v188, 0
    v_mov_b32 v189, 0
    v_mov_b32 v190, 0
    v_mov_b32 v191, 0
    v_max3_f32 v13, v192, v193, v194
    v_max3_f32 v14, v195, v196, v197
    v_max3_f32 v13, v13, v198, v199
    v_max3_f32 v14, v14, v200, v201
    v_max3_f32 v13, v13, v202, v203
    v_max3_f32 v14, v14, v204, v205
    v_max3_f32 v13, v13, v206, v207
    s_nop 0
    v_max3_f32 v14, v14, v208, v209
    v_max3_f32 v13, v13, v210, v211
    v_max3_f32 v14, v14, v212, v213
    v_max3_f32 v13, v13, v214, v215
    v_max3_f32 v14, v14, v216, v217
    v_max3_f32 v13, v13, v218, v219
    v_max3_f32 v14, v14, v220, v221
    v_max3_f32 v13, v13, v222, v223
    v_max_f32 v13, v13, v14
    v_mov_b32 v14, v13
    s_nop 1
    v_permlane32_swap_b32 v13, v14
    v_max_f32 v13, v13, v14
    v_sub_f32 v112, 0, v13
    v_sub_f32 v113, 0, v13
    v_sub_f32 v114, 0, v13
    v_sub_f32 v115, 0, v13
    v_sub_f32 v116, 0, v13
    v_sub_f32 v117, 0, v13
    v_sub_f32 v118, 0, v13
    v_sub_f32 v119, 0, v13
    v_sub_f32 v120, 0, v13
    v_sub_f32 v121, 0, v13
    v_sub_f32 v122, 0, v13
    v_sub_f32 v123, 0, v13
    v_sub_f32 v124, 0, v13
    v_sub_f32 v125, 0, v13
    v_sub_f32 v126, 0, v13
    v_sub_f32 v127, 0, v13
    v_sub_f32 v192, v192, v13
    v_sub_f32 v193, v193, v13
    v_sub_f32 v194, v194, v13
    v_sub_f32 v195, v195, v13
    v_sub_f32 v196, v196, v13
    v_sub_f32 v197, v197, v13
    v_sub_f32 v198, v198, v13
    v_sub_f32 v199, v199, v13
    v_sub_f32 v200, v200, v13
    v_sub_f32 v201, v201, v13
    v_sub_f32 v202, v202, v13
    v_sub_f32 v203, v203, v13
    v_sub_f32 v204, v204, v13
    v_sub_f32 v205, v205, v13
    v_sub_f32 v206, v206, v13
    v_sub_f32 v207, v207, v13
    v_sub_f32 v208, v208, v13
    v_sub_f32 v209, v209, v13
    v_sub_f32 v210, v210, v13
    v_sub_f32 v211, v211, v13
    v_sub_f32 v212, v212, v13
    v_sub_f32 v213, v213, v13
    v_sub_f32 v214, v214, v13
    v_sub_f32 v215, v215, v13
    v_sub_f32 v216, v216, v13
    v_sub_f32 v217, v217, v13
    v_sub_f32 v218, v218, v13
    v_sub_f32 v219, v219, v13
    v_sub_f32 v220, v220, v13
    v_sub_f32 v221, v221, v13
    v_sub_f32 v222, v222, v13
    v_sub_f32 v223, v223, v13
    s_mov_b32 s38, 3
    s_waitcnt vmcnt(4)
L_a_loop:
    s_waitcnt vmcnt(4)
    s_barrier
    ds_read_b128 v[104:107], v25 offset:32768
    s_waitcnt lgkmcnt(6)
    v_mfma_f32_32x32x16_bf16 v[224:239], v[80:83], v[32:35], v[112:127]
    v_exp_f32 v192, v192
    v_exp_f32 v193, v193
    v_exp_f32 v194, v194
    s_cmp_lt_u32 s33, s43
    s_cselect_b32 s37, s33, s44
    s_mov_b32 m0, s35
    s_add_u32 s33, s33, 16384
    buffer_load_dwordx4 v7, s[20:23], s37 offen lds
    ds_read_b128 v[108:111], v26 offset:32768
    s_waitcnt lgkmcnt(6)
    v_mfma_f32_32x32x16_bf16 v[224:239], v[84:87], v[36:39], v[224:239]
    v_exp_f32 v195, v195
    v_exp_f32 v196, v196
    v_add_f32 v11, v11, v192
    ds_read_b128 v[80:83], v19 offset:40960
    s_waitcnt lgkmcnt(6)
    v_mfma_f32_32x32x16_bf16 v[224:239], v[88:91], v[40:43], v[224:239]
    v_add_f32 v12, v12, v193
    v_exp_f32 v197, v197
    v_cvt_pk_bf16_f32 v64, v192, v193
    ds_read_b128 v[84:87], v20 offset:40960
    s_waitcnt lgkmcnt(6)
    v_mfma_f32_32x32x16_bf16 v[224:239], v[92:95], v[44:47], v[224:239]
    v_exp_f32 v198, v198
    v_add_f32 v11, v11, v194
    v_add_f32 v12, v12, v195
    buffer_load_dwordx4 v8, s[20:23], s37 offen offset:1024 lds
    s_add_u32 s35, s35, 32768
    s_and_b32 s35, s35, 0x1ffff
    ds_read_b128 v[88:91], v21 offset:40960
    s_waitcnt lgkmcnt(6)
    v_mfma_f32_32x32x16_bf16 v[224:239], v[96:99], v[48:51], v[224:239]
    v_exp_f32 v199, v199
    v_cvt_pk_bf16_f32 v65, v194, v195
    v_exp_f32 v200, v200
    ds_read_b128 v[92:95], v22 offset:40960
    s_waitcnt lgkmcnt(6)
    v_mfma_f32_32x32x16_bf16 v[224:239], v[100:103], v[52:55], v[224:239]
    v_add_f32 v11, v11, v196
    v_add_f32 v12, v12, v197
    v_exp_f32 v201, v201
    ds_read_b128 v[96:99], v23 offset:40960
    s_waitcnt lgkmcnt(6)
    v_mfma_f32_32x32x16_bf16 v[224:239], v[104:107], v[56:59], v[224:239]
    v_cvt_pk_bf16_f32 v66, v196, v197
    v_exp_f32 v202, v202
    v_add_f32 v11, v11, v198
    s_cmp_lt_u32 s34, s43
    s_cselect_b32 s37, s34, s44
    s_mov_b32 m0, s36
    s_add_u32 s34, s34, 16384
    buffer_load_dwordx4 v9, s[24:27], s37 offen lds
    ds_read_b128 v[100:103], v24 offset:40960
    s_waitcnt lgkmcnt(6)
    v_mfma_f32_32x32x16_bf16 v[224:239], v[108:111], v[60:63], v[224:239]
    v_add_f32 v12, v12, v199
    v_exp_f32 v203, v203
    v_cvt_pk_bf16_f32 v67, v198, v199
    ds_read_b128 v[104:107], v25 offset:40960
    s_waitcnt lgkmcnt(6)
    v_mfma_f32_32x32x16_bf16 v[240:255], v[80:83], v[32:35], v[112:127]
    v_exp_f32 v204, v204
    v_add_f32 v11, v11, v200
    v_add_f32 v12, v12, v201
    ds_read_b128 v[108:111], v26 offset:40960
    s_waitcnt lgkmcnt(6)
    v_mfma_f32_32x32x16_bf16 v[240:255], v[84:87], v[36:39], v[240:255]
    v_exp_f32 v205, v205
    v_cvt_pk_bf16_f32 v68, v200, v201
    v_exp_f32 v206, v206
    buffer_load_dwordx4 v9, s[24:27], s37 offen offset:1024 lds
    s_add_u32 s36, s36, 32768
    s_and_b32 s36, s36, 0x1ffff
    ds_read_b64_tr_b16 v[80:81], v15 offset:16384
    ds_read_b64_tr_b16 v[82:83], v15 offset:18432
    s_waitcnt lgkmcnt(7)
    v_mfma_f32_32x32x16_bf16 v[240:255], v[88:91], v[40:43], v[240:255]
    v_add_f32 v11, v11, v202
    v_add_f32 v12, v12, v203
    v_exp_f32 v207, v207
    ds_read_b64_tr_b16 v[84:85], v16 offset:16384
    ds_read_b64_tr_b16 v[86:87], v16 offset:18432
    s_waitcnt lgkmcnt(8)
    v_mfma_f32_32x32x16_bf16 v[240:255], v[92:95], v[44:47], v[240:255]
    v_cvt_pk_bf16_f32 v69, v202, v203
    v_exp_f32 v208, v208
    v_add_f32 v11, v11, v204
    ds_read_b64_tr_b16 v[88:89], v17 offset:16384
    ds_read_b64_tr_b16 v[90:91], v17 offset:18432
    s_waitcnt lgkmcnt(9)
    v_mfma_f32_32x32x16_bf16 v[240:255], v[96:99], v[48:51], v[240:255]
    v_add_f32 v12, v12, v205
    v_exp_f32 v209, v209
    v_cvt_pk_bf16_f32 v70, v204, v205
    ds_read_b64_tr_b16 v[92:93], v18 offset:16384
    ds_read_b64_tr_b16 v[94:95], v18 offset:18432
    s_waitcnt lgkmcnt(10)
    v_mfma_f32_32x32x16_bf16 v[240:255], v[100:103], v[52:55], v[240:255]
    v_exp_f32 v210, v210
    v_add_f32 v11, v11, v206
    v_add_f32 v12, v12, v207
    v_xor_b32 v19, 0x10000, v19
    v_xor_b32 v20, 0x10000, v20
    v_xor_b32 v21, 0x10000, v21
    v_xor_b32 v22, 0x10000, v22
    ds_read_b64_tr_b16 v[96:97], v15 offset:20480
    ds_read_b64_tr_b16 v[98:99], v15 offset:22528
    s_waitcnt lgkmcnt(11)
    v_mfma_f32_32x32x16_bf16 v[240:255], v[104:107], v[56:59], v[240:255]
    v_exp_f32 v211, v211
    v_cvt_pk_bf16_f32 v71, v206, v207
    v_exp_f32 v212, v212
    s_mov_b32 m0, s47
    s_nop 0
    buffer_load_dwordx4 v2, s[52:55], s61 offen lds
    ds_read_b64_tr_b16 v[100:101], v16 offset:20480
    ds_read_b64_tr_b16 v[102:103], v16 offset:22528
    s_waitcnt lgkmcnt(12)
    v_mfma_f32_32x32x16_bf16 v[240:255], v[108:111], v[60:63], v[240:255]
    v_add_f32 v11, v11, v208
    v_add_f32 v12, v12, v209
    v_exp_f32 v213, v213
    v_xor_b32 v23, 0x10000, v23
    v_xor_b32 v24, 0x10000, v24
    v_xor_b32 v25, 0x10000, v25
    v_xor_b32 v26, 0x10000, v26
    ds_read_b64_tr_b16 v[104:105], v17 offset:20480
    ds_read_b64_tr_b16 v[106:107], v17 offset:22528
    s_waitcnt lgkmcnt(12)
    v_mfma_f32_32x32x16_bf16 v[128:143], v[80:83], v[64:67], v[128:143]
    v_cvt_pk_bf16_f32 v72, v208, v209
    v_exp_f32 v214, v214
    v_add_f32 v11, v11, v210
    ds_read_b64_tr_b16 v[108:109], v18 offset:20480
    ds_read_b64_tr_b16 v[110:111], v18 offset:22528
    s_waitcnt lgkmcnt(12)
    v_mfma_f32_32x32x16_bf16 v[144:159], v[84:87], v[64:67], v[144:159]
    v_add_f32 v12, v12, v211
    v_exp_f32 v215, v215
    v_cvt_pk_bf16_f32 v73, v210, v211
    buffer_load_dwordx4 v2, s[56:59], s61 offen lds
    s_add_u32 s61, s61, 1024
    ds_read_b64_tr_b16 v[80:81], v15 offset:24576
    ds_read_b64_tr_b16 v[82:83], v15 offset:26624
    s_waitcnt lgkmcnt(12)
    v_mfma_f32_32x32x16_bf16 v[160:175], v[88:91], v[64:67], v[160:175]
    v_exp_f32 v216, v216
    v_add_f32 v11, v11, v212
    v_add_f32 v12, v12, v213
    ds_read_b64_tr_b16 v[84:85], v16 offset:24576
    ds_read_b64_tr_b16 v[86:87], v16 offset:26624
    s_waitcnt lgkmcnt(12)
    v_mfma_f32_32x32x16_bf16 v[176:191], v[92:95], v[64:67], v[176:191]
    v_exp_f32 v217, v217
    v_cvt_pk_bf16_f32 v74, v212, v213
    v_max3_f32 v13, v224, v225, v226
    v_exp_f32 v218, v218
    v_max3_f32 v14, v227, v228, v229
    ds_read_b64_tr_b16 v[88:89], v17 offset:24576
    ds_read_b64_tr_b16 v[90:91], v17 offset:26624
    s_waitcnt lgkmcnt(12)
    v_mfma_f32_32x32x16_bf16 v[128:143], v[96:99], v[68:71], v[128:143]
    v_add_f32 v11, v11, v214
    v_add_f32 v12, v12, v215
    v_max3_f32 v13, v13, v230, v231
    v_exp_f32 v219, v219
    ds_read_b64_tr_b16 v[92:93], v18 offset:24576
    ds_read_b64_tr_b16 v[94:95], v18 offset:26624
    s_waitcnt lgkmcnt(12)
    v_mfma_f32_32x32x16_bf16 v[144:159], v[100:103], v[68:71], v[144:159]
    v_cvt_pk_bf16_f32 v75, v214, v215
    v_exp_f32 v220, v220
    v_max3_f32 v14, v14, v232, v233
    v_add_f32 v11, v11, v216
    v_max3_f32 v13, v13, v234, v235
    ds_read_b64_tr_b16 v[96:97], v15 offset:28672
    ds_read_b64_tr_b16 v[98:99], v15 offset:30720
    s_waitcnt lgkmcnt(12)
    v_mfma_f32_32x32x16_bf16 v[160:175], v[104:107], v[68:71], v[160:175]
    v_add_f32 v12, v12, v217
    v_exp_f32 v221, v221
    v_max3_f32 v14, v14, v236, v237
    v_cvt_pk_bf16_f32 v76, v216, v217
    ds_read_b64_tr_b16 v[100:101], v16 offset:28672
    ds_read_b64_tr_b16 v[102:103], v16 offset:30720
    s_waitcnt lgkmcnt(12)
    v_mfma_f32_32x32x16_bf16 v[176:191], v[108:111], v[68:71], v[176:191]
    v_exp_f32 v222, v222
    v_add_f32 v11, v11, v218
    v_max3_f32 v13, v13, v238, v239
    v_add_f32 v12, v12, v219
    v_max3_f32 v14, v14, v240, v241
    ds_read_b64_tr_b16 v[104:105], v17 offset:28672
    ds_read_b64_tr_b16 v[106:107], v17 offset:30720
    s_waitcnt lgkmcnt(12)
    v_mfma_f32_32x32x16_bf16 v[128:143], v[80:83], v[72:75], v[128:143]
    v_exp_f32 v223, v223
    v_cvt_pk_bf16_f32 v77, v218, v219
    v_max3_f32 v13, v13, v242, v243
    v_add_f32 v11, v11, v220
    ds_read_b64_tr_b16 v[108:109], v18 offset:28672
    ds_read_b64_tr_b16 v[110:111], v18 offset:30720
    s_waitcnt lgkmcnt(12)
    v_mfma_f32_32x32x16_bf16 v[144:159], v[84:87], v[72:75], v[144:159]
    v_add_f32 v12, v12, v221
    v_cvt_pk_bf16_f32 v78, v220, v221
    v_max3_f32 v14, v14, v244, v245
    v_add_f32 v11, v11, v222
    v_max3_f32 v13, v13, v246, v247
    ds_read_b128 v[80:83], v19 offset:0
    s_waitcnt lgkmcnt(11)
    v_mfma_f32_32x32x16_bf16 v[160:175], v[88:91], v[72:75], v[160:175]
    v_add_f32 v12, v12, v223
    v_cvt_pk_bf16_f32 v79, v222, v223
    v_max3_f32 v14, v14, v248, v249
    ds_read_b128 v[84:87], v20 offset:0
    s_waitcnt lgkmcnt(10)
    v_mfma_f32_32x32x16_bf16 v[176:191], v[92:95], v[72:75], v[176:191]
    v_max3_f32 v13, v13, v250, v251
    v_max3_f32 v14, v14, v252, v253
    ds_read_b128 v[88:91], v21 offset:0
    s_waitcnt lgkmcnt(9)
    v_mfma_f32_32x32x16_bf16 v[128:143], v[96:99], v[76:79], v[128:143]
    v_max3_f32 v13, v13, v254, v255
    ds_read_b128 v[92:95], v22 offset:0
    s_waitcnt lgkmcnt(8)
    v_mfma_f32_32x32x16_bf16 v[144:159], v[100:103], v[76:79], v[144:159]
    v_max_f32 v13, v13, v14
    v_mov_b32 v14, v13
    ds_read_b128 v[96:99], v23 offset:0
    s_waitcnt lgkmcnt(7)
    v_mfma_f32_32x32x16_bf16 v[160:175], v[104:107], v[76:79], v[160:175]
    v_permlane32_swap_b32 v13, v14
    ds_read_b128 v[100:103], v24 offset:0
    s_waitcnt lgkmcnt(6)
    v_mfma_f32_32x32x16_bf16 v[176:191], v[108:111], v[76:79], v[176:191]
    v_max_f32 v13, v13, v14
    v_cmp_lt_f32 vcc, s40, v13
    s_nop 0
    s_cbranch_vccnz L_resc_e
L_back_e:
    s_waitcnt vmcnt(6)
    s_barrier
    ds_read_b128 v[104:107], v25 offset:0
    s_waitcnt lgkmcnt(6)
    v_mfma_f32_32x32x16_bf16 v[192:207], v[80:83], v[32:35], v[112:127]
    v_exp_f32 v224, v224
    v_exp_f32 v225, v225
    v_exp_f32 v226, v226
    s_cmp_lt_u32 s33, s43
    s_cselect_b32 s37, s33, s44
    s_mov_b32 m0, s35
    s_add_u32 s33, s33, 16384
    buffer_load_dwordx4 v7, s[20:23], s37 offen lds
    ds_read_b128 v[108:111], v26 offset:0
    s_waitcnt lgkmcnt(6)
    v_mfma_f32_32x32x16_bf16 v[192:207], v[84:87], v[36:39], v[192:207]
    v_exp_f32 v227, v227
    v_exp_f32 v228, v228
    v_add_f32 v11, v11, v224
    ds_read_b128 v[80:83], v19 offset:8192
    s_waitcnt lgkmcnt(6)
    v_mfma_f32_32x32x16_bf16 v[192:207], v[88:91], v[40:43], v[192:207]
    v_add_f32 v12, v12, v225
    v_exp_f32 v229, v229
    v_cvt_pk_bf16_f32 v64, v224, v225
    ds_read_b128 v[84:87], v20 offset:8192
    s_waitcnt lgkmcnt(6)
    v_mfma_f32_32x32x16_bf16 v[192:207], v[92:95], v[44:47], v[192:207]
    v_exp_f32 v230, v230
    v_add_f32 v11, v11, v226
    v_add_f32 v12, v12, v227
    buffer_load_dwordx4 v8, s[20:23], s37 offen offset:1024 lds
    s_add_u32 s35, s35, 32768
    s_and_b32 s35, s35, 0x1ffff
    ds_read_b128 v[88:91], v21 offset:8192
    s_waitcnt lgkmcnt(6)
    v_mfma_f32_32x32x16_bf16 v[192:207], v[96:99], v[48:51], v[192:207]
    v_exp_f32 v231, v231
    v_cvt_pk_bf16_f32 v65, v226, v227
    v_exp_f32 v232, v232
    ds_read_b128 v[92:95], v22 offset:8192
    s_waitcnt lgkmcnt(6)
    v_mfma_f32_32x32x16_bf16 v[192:207], v[100:103], v[52:55], v[192:207]
    v_add_f32 v11, v11, v228
    v_add_f32 v12, v12, v229
    v_exp_f32 v233, v233
    ds_read_b128 v[96:99], v23 offset:8192
    s_waitcnt lgkmcnt(6)
    v_mfma_f32_32x32x16_bf16 v[192:207], v[104:107], v[56:59], v[192:207]
    v_cvt_pk_bf16_f32 v66, v228, v229
    v_exp_f32 v234, v234
    v_add_f32 v11, v11, v230
    s_cmp_lt_u32 s34, s43
    s_cselect_b32 s37, s34, s44
    s_mov_b32 m0, s36
    s_add_u32 s34, s34, 16384
    buffer_load_dwordx4 v9, s[24:27], s37 offen lds
    ds_read_b128 v[100:103], v24 offset:8192
    s_waitcnt lgkmcnt(6)
    v_mfma_f32_32x32x16_bf16 v[192:207], v[108:111], v[60:63], v[192:207]
    v_add_f32 v12, v12, v231
    v_exp_f32 v235, v235
    v_cvt_pk_bf16_f32 v67, v230, v231
    ds_read_b128 v[104:107], v25 offset:8192
    s_waitcnt lgkmcnt(6)
    v_mfma_f32_32x32x16_bf16 v[208:223], v[80:83], v[32:35], v[112:127]
    v_exp_f32 v236, v236
    v_add_f32 v11, v11, v232
    v_add_f32 v12, v12, v233
    ds_read_b128 v[108:111], v26 offset:8192
    s_waitcnt lgkmcnt(6)
    v_mfma_f32_32x32x16_bf16 v[208:223], v[84:87], v[36:39], v[208:223]
    v_exp_f32 v237, v237
    v_cvt_pk_bf16_f32 v68, v232, v233
    v_exp_f32 v238, v238
    buffer_load_dwordx4 v9, s[24:27], s37 offen offset:1024 lds
    s_add_u32 s36, s36, 32768
    s_and_b32 s36, s36, 0x1ffff
    ds_read_b64_tr_b16 v[80:81], v15 offset:49152
    ds_read_b64_tr_b16 v[82:83], v15 offset:51200
    s_waitcnt lgkmcnt(7)
    v_mfma_f32_32x32x16_bf16 v[208:223], v[88:91], v[40:43], v[208:223]
    v_add_f32 v11, v11, v234
    v_add_f32 v12, v12, v235
    v_exp_f32 v239, v239
    ds_read_b64_tr_b16 v[84:85], v16 offset:49152
    ds_read_b64_tr_b16 v[86:87], v16 offset:51200
    s_waitcnt lgkmcnt(8)
    v_mfma_f32_32x32x16_bf16 v[208:223], v[92:95], v[44:47], v[208:223]
    v_cvt_pk_bf16_f32 v69, v234, v235
    v_exp_f32 v240, v240
    v_add_f32 v11, v11, v236
    ds_read_b64_tr_b16 v[88:89], v17 offset:49152
    ds_read_b64_tr_b16 v[90:91], v17 offset:51200
    s_waitcnt lgkmcnt(9)
    v_mfma_f32_32x32x16_bf16 v[208:223], v[96:99], v[48:51], v[208:223]
    v_add_f32 v12, v12, v237
    v_exp_f32 v241, v241
    v_cvt_pk_bf16_f32 v70, v236, v237
    ds_read_b64_tr_b16 v[92:93], v18 offset:49152
    ds_read_b64_tr_b16 v[94:95], v18 offset:51200
    s_waitcnt lgkmcnt(10)
    v_mfma_f32_32x32x16_bf16 v[208:223], v[100:103], v[52:55], v[208:223]
    v_exp_f32 v242, v242
    v_add_f32 v11, v11, v238
    v_add_f32 v12, v12, v239
    ds_read_b64_tr_b16 v[96:97], v15 offset:53248
    ds_read_b64_tr_b16 v[98:99], v15 offset:55296
    s_waitcnt lgkmcnt(11)
    v_mfma_f32_32x32x16_bf16 v[208:223], v[104:107], v[56:59], v[208:223]
    v_exp_f32 v243, v243
    v_cvt_pk_bf16_f32 v71, v238, v239
    v_exp_f32 v244, v244
    s_cmp_eq_u32 s38, 1
    s_cbranch_scc1 L_pfskip
    s_mov_b32 m0, s47
    s_nop 0
    buffer_load_dwordx4 v2, s[48:51], s60 offen lds
    s_add_u32 s60, s60, 1024
L_pfskip:
    ds_read_b64_tr_b16 v[100:101], v16 offset:53248
    ds_read_b64_tr_b16 v[102:103], v16 offset:55296
    s_waitcnt lgkmcnt(12)
    v_mfma_f32_32x32x16_bf16 v[208:223], v[108:111], v[60:63], v[208:223]
    v_add_f32 v11, v11, v240
    v_add_f32 v12, v12, v241
    v_exp_f32 v245, v245
    ds_read_b64_tr_b16 v[104:105], v17 offset:53248
    ds_read_b64_tr_b16 v[106:107], v17 offset:55296
    s_waitcnt lgkmcnt(12)
    v_mfma_f32_32x32x16_bf16 v[128:143], v[80:83], v[64:67], v[128:143]
    v_cvt_pk_bf16_f32 v72, v240, v241
    v_exp_f32 v246, v246
    v_add_f32 v11, v11, v242
    ds_read_b64_tr_b16 v[108:109], v18 offset:53248
    ds_read_b64_tr_b16 v[110:111], v18 offset:55296
    s_waitcnt lgkmcnt(12)
    v_mfma_f32_32x32x16_bf16 v[144:159], v[84:87], v[64:67], v[144:159]
    v_add_f32 v12, v12, v243
    v_exp_f32 v247, v247
    v_cvt_pk_bf16_f32 v73, v242, v243
    ds_read_b64_tr_b16 v[80:81], v15 offset:57344
    ds_read_b64_tr_b16 v[82:83], v15 offset:59392
    s_waitcnt lgkmcnt(12)
    v_mfma_f32_32x32x16_bf16 v[160:175], v[88:91], v[64:67], v[160:175]
    v_exp_f32 v248, v248
    v_add_f32 v11, v11, v244
    v_add_f32 v12, v12, v245
    ds_read_b64_tr_b16 v[84:85], v16 offset:57344
    ds_read_b64_tr_b16 v[86:87], v16 offset:59392
    s_waitcnt lgkmcnt(12)
    v_mfma_f32_32x32x16_bf16 v[176:191], v[92:95], v[64:67], v[176:191]
    v_exp_f32 v249, v249
    v_cvt_pk_bf16_f32 v74, v244, v245
    v_max3_f32 v13, v192, v193, v194
    v_exp_f32 v250, v250
    v_max3_f32 v14, v195, v196, v197
    ds_read_b64_tr_b16 v[88:89], v17 offset:57344
    ds_read_b64_tr_b16 v[90:91], v17 offset:59392
    s_waitcnt lgkmcnt(12)
    v_mfma_f32_32x32x16_bf16 v[128:143], v[96:99], v[68:71], v[128:143]
    v_add_f32 v11, v11, v246
    v_add_f32 v12, v12, v247
    v_max3_f32 v13, v13, v198, v199
    v_exp_f32 v251, v251
    ds_read_b64_tr_b16 v[92:93], v18 offset:57344
    ds_read_b64_tr_b16 v[94:95], v18 offset:59392
    s_waitcnt lgkmcnt(12)
    v_mfma_f32_32x32x16_bf16 v[144:159], v[100:103], v[68:71], v[144:159]
    v_cvt_pk_bf16_f32 v75, v246, v247
    v_exp_f32 v252, v252
    v_max3_f32 v14, v14, v200, v201
    v_add_f32 v11, v11, v248
    v_max3_f32 v13, v13, v202, v203
    ds_read_b64_tr_b16 v[96:97], v15 offset:61440
    ds_read_b64_tr_b16 v[98:99], v15 offset:63488
    s_waitcnt lgkmcnt(12)
    v_mfma_f32_32x32x16_bf16 v[160:175], v[104:107], v[68:71], v[160:175]
    v_add_f32 v12, v12, v249
    v_exp_f32 v253, v253
    v_max3_f32 v14, v14, v204, v205
    v_cvt_pk_bf16_f32 v76, v248, v249
    ds_read_b64_tr_b16 v[100:101], v16 offset:61440
    ds_read_b64_tr_b16 v[102:103], v16 offset:63488
    s_waitcnt lgkmcnt(12)
    v_mfma_f32_32x32x16_bf16 v[176:191], v[108:111], v[68:71], v[176:191]
    v_exp_f32 v254, v254
    v_add_f32 v11, v11, v250
    v_max3_f32 v13, v13, v206, v207
    v_add_f32 v12, v12, v251
    v_max3_f32 v14, v14, v208, v209
    ds_read_b64_tr_b16 v[104:105], v17 offset:61440
    ds_read_b64_tr_b16 v[106:107], v17 offset:63488
    s_waitcnt lgkmcnt(12)
    v_mfma_f32_32x32x16_bf16 v[128:143], v[80:83], v[72:75], v[128:143]
    v_exp_f32 v255, v255
    v_cvt_pk_bf16_f32 v77, v250, v251
    v_max3_f32 v13, v13, v210, v211
    v_add_f32 v11, v11, v252
    ds_read_b64_tr_b16 v[108:109], v18 offset:61440
    ds_read_b64_tr_b16 v[110:111], v18 offset:63488
    s_waitcnt lgkmcnt(12)
    v_mfma_f32_32x32x16_bf16 v[144:159], v[84:87], v[72:75], v[144:159]
    v_add_f32 v12, v12, v253
    v_cvt_pk_bf16_f32 v78, v252, v253
    v_max3_f32 v14, v14, v212, v213
    v_add_f32 v11, v11, v254
    v_max3_f32 v13, v13, v214, v215
    ds_read_b128 v[80:83], v19 offset:32768
    s_waitcnt lgkmcnt(11)
    v_mfma_f32_32x32x16_bf16 v[160:175], v[88:91], v[72:75], v[160:175]
    v_add_f32 v12, v12, v255
    v_cvt_pk_bf16_f32 v79, v254, v255
    v_max3_f32 v14, v14, v216, v217
    ds_read_b128 v[84:87], v20 offset:32768
    s_waitcnt lgkmcnt(10)
    v_mfma_f32_32x32x16_bf16 v[176:191], v[92:95], v[72:75], v[176:191]
    v_max3_f32 v13, v13, v218, v219
    v_max3_f32 v14, v14, v220, v221
    v_xor_b32 v15, 0x10000, v15
    v_xor_b32 v16, 0x10000, v16
    v_xor_b32 v17, 0x10000, v17
    v_xor_b32 v18, 0x10000, v18
    ds_read_b128 v[88:91], v21 offset:32768
    s_waitcnt lgkmcnt(9)
    v_mfma_f32_32x32x16_bf16 v[128:143], v[96:99], v[76:79], v[128:143]
    v_max3_f32 v13, v13, v222, v223
    ds_read_b128 v[92:95], v22 offset:32768
    s_waitcnt lgkmcnt(8)
    v_mfma_f32_32x32x16_bf16 v[144:159], v[100:103], v[76:79], v[144:159]
    v_max_f32 v13, v13, v14
    v_mov_b32 v14, v13
    ds_read_b128 v[96:99], v23 offset:32768
    s_waitcnt lgkmcnt(7)
    v_mfma_f32_32x32x16_bf16 v[160:175], v[104:107], v[76:79], v[160:175]
    v_permlane32_swap_b32 v13, v14
    ds_read_b128 v[100:103], v24 offset:32768
    s_waitcnt lgkmcnt(6)
    v_mfma_f32_32x32x16_bf16 v[176:191], v[108:111], v[76:79], v[176:191]
    v_max_f32 v13, v13, v14
    v_cmp_lt_f32 vcc, s40, v13
    s_nop 0
    s_cbranch_vccnz L_resc_o
L_back_o:
    s_sub_u32 s38, s38, 1
    s_cmp_lg_u32 s38, 0
    s_cbranch_scc1 L_a_loop
    s_waitcnt vmcnt(0)
    s_barrier
    ds_read_b128 v[104:107], v25 offset:32768
    s_waitcnt lgkmcnt(6)
    v_mfma_f32_32x32x16_bf16 v[224:239], v[80:83], v[32:35], v[112:127]
    v_exp_f32 v192, v192
    v_exp_f32 v193, v193
    v_exp_f32 v194, v194
    s_add_u32 m0, s41, 0
    s_nop 0
    buffer_load_dwordx4 v5, s[52:55], s62 offen lds
    ds_read_b128 v[108:111], v26 offset:32768
    s_waitcnt lgkmcnt(6)
    v_mfma_f32_32x32x16_bf16 v[224:239], v[84:87], v[36:39], v[224:239]
    v_exp_f32 v195, v195
    v_exp_f32 v196, v196
    v_add_f32 v11, v11, v192
    ds_read_b128 v[80:83], v19 offset:40960
    s_waitcnt lgkmcnt(6)
    v_mfma_f32_32x32x16_bf16 v[224:239], v[88:91], v[40:43], v[224:239]
    v_add_f32 v12, v12, v193
    v_exp_f32 v197, v197
    v_cvt_pk_bf16_f32 v64, v192, v193
    ds_read_b128 v[84:87], v20 offset:40960
    s_waitcnt lgkmcnt(6)
    v_mfma_f32_32x32x16_bf16 v[224:239], v[92:95], v[44:47], v[224:239]
    v_exp_f32 v198, v198
    v_add_f32 v11, v11, v194
    v_add_f32 v12, v12, v195
    buffer_load_dwordx4 v6, s[52:55], s62 offen offset:1024 lds
    s_add_u32 s62, s62, 229376
    ds_read_b128 v[88:91], v21 offset:40960
    s_waitcnt lgkmcnt(6)
    v_mfma_f32_32x32x16_bf16 v[224:239], v[96:99], v[48:51], v[224:239]
    v_exp_f32 v199, v199
    v_cvt_pk_bf16_f32 v65, v194, v195
    v_exp_f32 v200, v200
    ds_read_b128 v[92:95], v22 offset:40960
    s_waitcnt lgkmcnt(6)
    v_mfma_f32_32x32x16_bf16 v[224:239], v[100:103], v[52:55], v[224:239]
    v_add_f32 v11, v11, v196
    v_add_f32 v12, v12, v197
    v_exp_f32 v201, v201
    ds_read_b128 v[96:99], v23 offset:40960
    s_waitcnt lgkmcnt(6)
    v_mfma_f32_32x32x16_bf16 v[224:239], v[104:107], v[56:59], v[224:239]
    v_cvt_pk_bf16_f32 v66, v196, v197
    v_exp_f32 v202, v202
    v_add_f32 v11, v11, v198
    s_add_u32 m0, s45, 16384
    s_nop 0
    buffer_load_dwordx4 v2, s[12:15], s63 offen lds
    s_add_u32 s63, s63, 4096
    ds_read_b128 v[100:103], v24 offset:40960
    s_waitcnt lgkmcnt(6)
    v_mfma_f32_32x32x16_bf16 v[224:239], v[108:111], v[60:63], v[224:239]
    v_add_f32 v12, v12, v199
    v_exp_f32 v203, v203
    v_cvt_pk_bf16_f32 v67, v198, v199
    ds_read_b128 v[104:107], v25 offset:40960
    s_waitcnt lgkmcnt(6)
    v_mfma_f32_32x32x16_bf16 v[240:255], v[80:83], v[32:35], v[112:127]
    v_exp_f32 v204, v204
    v_add_f32 v11, v11, v200
    v_add_f32 v12, v12, v201
    ds_read_b128 v[108:111], v26 offset:40960
    s_waitcnt lgkmcnt(6)
    v_mfma_f32_32x32x16_bf16 v[240:255], v[84:87], v[36:39], v[240:255]
    v_exp_f32 v205, v205
    v_cvt_pk_bf16_f32 v68, v200, v201
    v_exp_f32 v206, v206
    s_add_u32 m0, s41, 24576
    s_nop 0
    buffer_load_dwordx4 v5, s[52:55], s62 offen lds
    ds_read_b64_tr_b16 v[80:81], v15 offset:16384
    ds_read_b64_tr_b16 v[82:83], v15 offset:18432
    s_waitcnt lgkmcnt(7)
    v_mfma_f32_32x32x16_bf16 v[240:255], v[88:91], v[40:43], v[240:255]
    v_add_f32 v11, v11, v202
    v_add_f32 v12, v12, v203
    v_exp_f32 v207, v207
    ds_read_b64_tr_b16 v[84:85], v16 offset:16384
    ds_read_b64_tr_b16 v[86:87], v16 offset:18432
    s_waitcnt lgkmcnt(8)
    v_mfma_f32_32x32x16_bf16 v[240:255], v[92:95], v[44:47], v[240:255]
    v_cvt_pk_bf16_f32 v69, v202, v203
    v_exp_f32 v208, v208
    v_add_f32 v11, v11, v204
    ds_read_b64_tr_b16 v[88:89], v17 offset:16384
    ds_read_b64_tr_b16 v[90:91], v17 offset:18432
    s_waitcnt lgkmcnt(9)
    v_mfma_f32_32x32x16_bf16 v[240:255], v[96:99], v[48:51], v[240:255]
    v_add_f32 v12, v12, v205
    v_exp_f32 v209, v209
    v_cvt_pk_bf16_f32 v70, v204, v205
    buffer_load_dwordx4 v6, s[52:55], s62 offen offset:1024 lds
    s_add_u32 s62, s62, 229376
    ds_read_b64_tr_b16 v[92:93], v18 offset:16384
    ds_read_b64_tr_b16 v[94:95], v18 offset:18432
    s_waitcnt lgkmcnt(10)
    v_mfma_f32_32x32x16_bf16 v[240:255], v[100:103], v[52:55], v[240:255]
    v_exp_f32 v210, v210
    v_add_f32 v11, v11, v206
    v_add_f32 v12, v12, v207
    ds_read_b64_tr_b16 v[96:97], v15 offset:20480
    ds_read_b64_tr_b16 v[98:99], v15 offset:22528
    s_waitcnt lgkmcnt(11)
    v_mfma_f32_32x32x16_bf16 v[240:255], v[104:107], v[56:59], v[240:255]
    v_exp_f32 v211, v211
    v_cvt_pk_bf16_f32 v71, v206, v207
    v_exp_f32 v212, v212
    ds_read_b64_tr_b16 v[100:101], v16 offset:20480
    ds_read_b64_tr_b16 v[102:103], v16 offset:22528
    s_waitcnt lgkmcnt(12)
    v_mfma_f32_32x32x16_bf16 v[240:255], v[108:111], v[60:63], v[240:255]
    v_add_f32 v11, v11, v208
    v_add_f32 v12, v12, v209
    v_exp_f32 v213, v213
    s_add_u32 m0, s45, 40960
    s_nop 0
    buffer_load_dwordx4 v2, s[12:15], s63 offen lds
    s_add_u32 s63, s63, 4096
    ds_read_b64_tr_b16 v[104:105], v17 offset:20480
    ds_read_b64_tr_b16 v[106:107], v17 offset:22528
    s_waitcnt lgkmcnt(12)
    v_mfma_f32_32x32x16_bf16 v[128:143], v[80:83], v[64:67], v[128:143]
    v_cvt_pk_bf16_f32 v72, v208, v209
    v_exp_f32 v214, v214
    v_add_f32 v11, v11, v210
    ds_read_b64_tr_b16 v[108:109], v18 offset:20480
    ds_read_b64_tr_b16 v[110:111], v18 offset:22528
    s_waitcnt lgkmcnt(12)
    v_mfma_f32_32x32x16_bf16 v[144:159], v[84:87], v[64:67], v[144:159]
    v_add_f32 v12, v12, v211
    v_exp_f32 v215, v215
    v_cvt_pk_bf16_f32 v73, v210, v211
    ds_read_b64_tr_b16 v[80:81], v15 offset:24576
    ds_read_b64_tr_b16 v[82:83], v15 offset:26624
    s_waitcnt lgkmcnt(12)
    v_mfma_f32_32x32x16_bf16 v[160:175], v[88:91], v[64:67], v[160:175]
    v_exp_f32 v216, v216
    v_add_f32 v11, v11, v212
    v_add_f32 v12, v12, v213
    ds_read_b64_tr_b16 v[84:85], v16 offset:24576
    ds_read_b64_tr_b16 v[86:87], v16 offset:26624
    s_waitcnt lgkmcnt(12)
    v_mfma_f32_32x32x16_bf16 v[176:191], v[92:95], v[64:67], v[176:191]
    v_exp_f32 v217, v217
    v_cvt_pk_bf16_f32 v74, v212, v213
    v_max3_f32 v13, v224, v225, v226
    v_exp_f32 v218, v218
    v_max3_f32 v14, v227, v228, v229
    ds_read_b64_tr_b16 v[88:89], v17 offset:24576
    ds_read_b64_tr_b16 v[90:91], v17 offset:26624
    s_waitcnt lgkmcnt(12)
    v_mfma_f32_32x32x16_bf16 v[128:143], v[96:99], v[68:71], v[128:143]
    v_add_f32 v11, v11, v214
    v_add_f32 v12, v12, v215
    v_max3_f32 v13, v13, v230, v231
    v_exp_f32 v219, v219
    ds_read_b64_tr_b16 v[92:93], v18 offset:24576
    ds_read_b64_tr_b16 v[94:95], v18 offset:26624
    s_waitcnt lgkmcnt(12)
    v_mfma_f32_32x32x16_bf16 v[144:159], v[100:103], v[68:71], v[144:159]
    v_cvt_pk_bf16_f32 v75, v214, v215
    v_exp_f32 v220, v220
    v_max3_f32 v14, v14, v232, v233
    v_add_f32 v11, v11, v216
    v_max3_f32 v13, v13, v234, v235
    ds_read_b64_tr_b16 v[96:97], v15 offset:28672
    ds_read_b64_tr_b16 v[98:99], v15 offset:30720
    s_waitcnt lgkmcnt(12)
    v_mfma_f32_32x32x16_bf16 v[160:175], v[104:107], v[68:71], v[160:175]
    v_add_f32 v12, v12, v217
    v_exp_f32 v221, v221
    v_max3_f32 v14, v14, v236, v237
    v_cvt_pk_bf16_f32 v76, v216, v217
    ds_read_b64_tr_b16 v[100:101], v16 offset:28672
    ds_read_b64_tr_b16 v[102:103], v16 offset:30720
    s_waitcnt lgkmcnt(12)
    v_mfma_f32_32x32x16_bf16 v[176:191], v[108:111], v[68:71], v[176:191]
    v_exp_f32 v222, v222
    v_add_f32 v11, v11, v218
    v_max3_f32 v13, v13, v238, v239
    v_add_f32 v12, v12, v219
    v_max3_f32 v14, v14, v240, v241
    ds_read_b64_tr_b16 v[104:105], v17 offset:28672
    ds_read_b64_tr_b16 v[106:107], v17 offset:30720
    s_waitcnt lgkmcnt(12)
    v_mfma_f32_32x32x16_bf16 v[128:143], v[80:83], v[72:75], v[128:143]
    v_exp_f32 v223, v223
    v_cvt_pk_bf16_f32 v77, v218, v219
    v_max3_f32 v13, v13, v242, v243
    v_add_f32 v11, v11, v220
    ds_read_b64_tr_b16 v[108:109], v18 offset:28672
    ds_read_b64_tr_b16 v[110:111], v18 offset:30720
    s_waitcnt lgkmcnt(12)
    v_mfma_f32_32x32x16_bf16 v[144:159], v[84:87], v[72:75], v[144:159]
    v_add_f32 v12, v12, v221
    v_cvt_pk_bf16_f32 v78, v220, v221
    v_max3_f32 v14, v14, v244, v245
    v_add_f32 v11, v11, v222
    v_max3_f32 v13, v13, v246, v247
    ds_read_b64_tr_b16 v[80:81], v15 offset:49152
    ds_read_b64_tr_b16 v[82:83], v15 offset:51200
    s_waitcnt lgkmcnt(12)
    v_mfma_f32_32x32x16_bf16 v[160:175], v[88:91], v[72:75], v[160:175]
    v_add_f32 v12, v12, v223
    v_cvt_pk_bf16_f32 v79, v222, v223
    v_max3_f32 v14, v14, v248, v249
    ds_read_b64_tr_b16 v[84:85], v16 offset:49152
    ds_read_b64_tr_b16 v[86:87], v16 offset:51200
    s_waitcnt lgkmcnt(12)
    v_mfma_f32_32x32x16_bf16 v[176:191], v[92:95], v[72:75], v[176:191]
    v_max3_f32 v13, v13, v250, v251
    v_max3_f32 v14, v14, v252, v253
    ds_read_b64_tr_b16 v[88:89], v17 offset:49152
    ds_read_b64_tr_b16 v[90:91], v17 offset:51200
    s_waitcnt lgkmcnt(12)
    v_mfma_f32_32x32x16_bf16 v[128:143], v[96:99], v[76:79], v[128:143]
    v_max3_f32 v13, v13, v254, v255
    ds_read_b64_tr_b16 v[92:93], v18 offset:49152
    ds_read_b64_tr_b16 v[94:95], v18 offset:51200
    s_waitcnt lgkmcnt(12)
    v_mfma_f32_32x32x16_bf16 v[144:159], v[100:103], v[76:79], v[144:159]
    v_max_f32 v13, v13, v14
    v_mov_b32 v14, v13
    ds_read_b64_tr_b16 v[96:97], v15 offset:53248
    ds_read_b64_tr_b16 v[98:99], v15 offset:55296
    s_waitcnt lgkmcnt(12)
    v_mfma_f32_32x32x16_bf16 v[160:175], v[104:107], v[76:79], v[160:175]
    v_permlane32_swap_b32 v13, v14
    ds_read_b64_tr_b16 v[100:101], v16 offset:53248
    ds_read_b64_tr_b16 v[102:103], v16 offset:55296
    s_waitcnt lgkmcnt(12)
    v_mfma_f32_32x32x16_bf16 v[176:191], v[108:111], v[76:79], v[176:191]
    v_max_f32 v13, v13, v14
    v_cmp_lt_f32 vcc, s40, v13
    s_nop 0
    s_cbranch_vccnz L_resc_p
L_back_p:
    s_barrier
    v_exp_f32 v224, v224
    v_exp_f32 v225, v225
    v_exp_f32 v226, v226
    v_exp_f32 v227, v227
    v_exp_f32 v228, v228
    v_add_f32 v11, v11, v224
    v_add_f32 v12, v12, v225
    v_exp_f32 v229, v229
    v_cvt_pk_bf16_f32 v64, v224, v225
    v_exp_f32 v230, v230
    v_add_f32 v11, v11, v226
    v_add_f32 v12, v12, v227
    v_exp_f32 v231, v231
    v_cvt_pk_bf16_f32 v65, v226, v227
    v_exp_f32 v232, v232
    v_add_f32 v11, v11, v228
    v_add_f32 v12, v12, v229
    v_exp_f32 v233, v233
    v_cvt_pk_bf16_f32 v66, v228, v229
    v_exp_f32 v234, v234
    v_add_f32 v11, v11, v230
    v_add_f32 v12, v12, v231
    v_exp_f32 v235, v235
    v_cvt_pk_bf16_f32 v67, v230, v231
    ds_read_b64_tr_b16 v[104:105], v17 offset:53248
    ds_read_b64_tr_b16 v[106:107], v17 offset:55296
    s_waitcnt lgkmcnt(12)
    v_mfma_f32_32x32x16_bf16 v[128:143], v[80:83], v[64:67], v[128:143]
    v_exp_f32 v236, v236
    v_add_f32 v11, v11, v232
    v_add_f32 v12, v12, v233
    v_exp_f32 v237, v237
    v_cvt_pk_bf16_f32 v68, v232, v233
    v_exp_f32 v238, v238
    s_add_u32 m0, s41, 49152
    s_nop 0
    buffer_load_dwordx4 v5, s[52:55], s62 offen lds
    ds_read_b64_tr_b16 v[108:109], v18 offset:53248
    ds_read_b64_tr_b16 v[110:111], v18 offset:55296
    s_waitcnt lgkmcnt(12)
    v_mfma_f32_32x32x16_bf16 v[144:159], v[84:87], v[64:67], v[144:159]
    v_add_f32 v11, v11, v234
    v_add_f32 v12, v12, v235
    v_exp_f32 v239, v239
    v_cvt_pk_bf16_f32 v69, v234, v235
    v_exp_f32 v240, v240
    ds_read_b64_tr_b16 v[80:81], v15 offset:57344
    ds_read_b64_tr_b16 v[82:83], v15 offset:59392
    s_waitcnt lgkmcnt(12)
    v_mfma_f32_32x32x16_bf16 v[160:175], v[88:91], v[64:67], v[160:175]
    v_add_f32 v11, v11, v236
    v_add_f32 v12, v12, v237
    v_exp_f32 v241, v241
    v_cvt_pk_bf16_f32 v70, v236, v237
    v_exp_f32 v242, v242
    buffer_load_dwordx4 v6, s[52:55], s62 offen offset:1024 lds
    s_add_u32 s62, s62, 229376
    ds_read_b64_tr_b16 v[84:85], v16 offset:57344
    ds_read_b64_tr_b16 v[86:87], v16 offset:59392
    s_waitcnt lgkmcnt(12)
    v_mfma_f32_32x32x16_bf16 v[176:191], v[92:95], v[64:67], v[176:191]
    v_add_f32 v11, v11, v238
    v_add_f32 v12, v12, v239
    v_exp_f32 v243, v243
    v_cvt_pk_bf16_f32 v71, v238, v239
    v_exp_f32 v244, v244
    ds_read_b64_tr_b16 v[88:89], v17 offset:57344
    ds_read_b64_tr_b16 v[90:91], v17 offset:59392
    s_waitcnt lgkmcnt(12)
    v_mfma_f32_32x32x16_bf16 v[128:143], v[96:99], v[68:71], v[128:143]
    v_add_f32 v11, v11, v240
    v_add_f32 v12, v12, v241
    v_exp_f32 v245, v245
    v_cvt_pk_bf16_f32 v72, v240, v241
    v_exp_f32 v246, v246
    s_add_u32 m0, s45, 65536
    s_nop 0
    buffer_load_dwordx4 v2, s[12:15], s63 offen lds
    s_add_u32 s63, s63, 4096
    ds_read_b64_tr_b16 v[92:93], v18 offset:57344
    ds_read_b64_tr_b16 v[94:95], v18 offset:59392
    s_waitcnt lgkmcnt(12)
    v_mfma_f32_32x32x16_bf16 v[144:159], v[100:103], v[68:71], v[144:159]
    v_add_f32 v11, v11, v242
    v_add_f32 v12, v12, v243
    v_exp_f32 v247, v247
    v_cvt_pk_bf16_f32 v73, v242, v243
    v_exp_f32 v248, v248
    ds_read_b64_tr_b16 v[96:97], v15 offset:61440
    ds_read_b64_tr_b16 v[98:99], v15 offset:63488
    s_waitcnt lgkmcnt(12)
    v_mfma_f32_32x32x16_bf16 v[160:175], v[104:107], v[68:71], v[160:175]
    v_add_f32 v11, v11, v244
    v_add_f32 v12, v12, v245
    v_exp_f32 v249, v249
    v_cvt_pk_bf16_f32 v74, v244, v245
    v_exp_f32 v250, v250
    s_add_u32 m0, s41, 73728
    s_nop 0
    buffer_load_dwordx4 v5, s[52:55], s62 offen lds
    ds_read_b64_tr_b16 v[100:101], v16 offset:61440
    ds_read_b64_tr_b16 v[102:103], v16 offset:63488
    s_waitcnt lgkmcnt(12)
    v_mfma_f32_32x32x16_bf16 v[176:191], v[108:111], v[68:71], v[176:191]
    v_add_f32 v11, v11, v246
    v_add_f32 v12, v12, v247
    v_exp_f32 v251, v251
    v_cvt_pk_bf16_f32 v75, v246, v247
    v_exp_f32 v252, v252
    ds_read_b64_tr_b16 v[104:105], v17 offset:61440
    ds_read_b64_tr_b16 v[106:107], v17 offset:63488
    s_waitcnt lgkmcnt(12)
    v_mfma_f32_32x32x16_bf16 v[128:143], v[80:83], v[72:75], v[128:143]
    v_add_f32 v11, v11, v248
    v_add_f32 v12, v12, v249
    v_exp_f32 v253, v253
    v_cvt_pk_bf16_f32 v76, v248, v249
    v_exp_f32 v254, v254
    buffer_load_dwordx4 v6, s[52:55], s62 offen offset:1024 lds
    s_add_u32 s62, s62, 229376
    ds_read_b64_tr_b16 v[108:109], v18 offset:61440
    ds_read_b64_tr_b16 v[110:111], v18 offset:63488
    s_waitcnt lgkmcnt(12)
    v_mfma_f32_32x32x16_bf16 v[144:159], v[84:87], v[72:75], v[144:159]
    v_add_f32 v11, v11, v250
    v_add_f32 v12, v12, v251
    v_exp_f32 v255, v255
    v_cvt_pk_bf16_f32 v77, v250, v251
    v_add_f32 v11, v11, v252
    s_waitcnt lgkmcnt(10)
    v_mfma_f32_32x32x16_bf16 v[160:175], v[88:91], v[72:75], v[160:175]
    v_add_f32 v12, v12, v253
    v_cvt_pk_bf16_f32 v78, v252, v253
    v_add_f32 v11, v11, v254
    v_add_f32 v12, v12, v255
    v_cvt_pk_bf16_f32 v79, v254, v255
    s_add_u32 m0, s45, 90112
    s_nop 0
    buffer_load_dwordx4 v2, s[12:15], s63 offen lds
    s_add_u32 s63, s63, 4096
    s_waitcnt lgkmcnt(8)
    v_mfma_f32_32x32x16_bf16 v[176:191], v[92:95], v[72:75], v[176:191]
    s_waitcnt lgkmcnt(6)
    v_mfma_f32_32x32x16_bf16 v[128:143], v[96:99], v[76:79], v[128:143]
    s_waitcnt lgkmcnt(4)
    v_mfma_f32_32x32x16_bf16 v[144:159], v[100:103], v[76:79], v[144:159]
    s_waitcnt lgkmcnt(2)
    v_mfma_f32_32x32x16_bf16 v[160:175], v[104:107], v[76:79], v[160:175]
    s_waitcnt lgkmcnt(0)
    v_mfma_f32_32x32x16_bf16 v[176:191], v[108:111], v[76:79], v[176:191]
    v_add_f32 v11, v11, v12
    v_mov_b32 v12, v11
    s_nop 1
    v_permlane32_swap_b32 v11, v12
    v_add_f32 v11, v11, v12
    v_rcp_f32 v11, v11
    s_lshl_b32 s37, s31, 18
    s_lshl_b32 s42, s28, 13
    s_add_u32 s37, s37, s42
    s_add_u32 s37, s37, 4194304
    s_add_u32 s42, s37, 4096
    v_mul_f32 v128, v128, v11
    v_mul_f32 v129, v129, v11
    v_mul_f32 v130, v130, v11
    v_mul_f32 v131, v131, v11
    v_mul_f32 v132, v132, v11
    v_mul_f32 v133, v133, v11
    v_mul_f32 v134, v134, v11
    v_mul_f32 v135, v135, v11
    v_mul_f32 v136, v136, v11
    v_mul_f32 v137, v137, v11
    v_mul_f32 v138, v138, v11
    v_mul_f32 v139, v139, v11
    v_mul_f32 v140, v140, v11
    v_mul_f32 v141, v141, v11
    v_mul_f32 v142, v142, v11
    v_mul_f32 v143, v143, v11
    v_cvt_pk_bf16_f32 v64, v128, v129
    v_cvt_pk_bf16_f32 v65, v130, v131
    v_cvt_pk_bf16_f32 v66, v132, v133
    v_cvt_pk_bf16_f32 v67, v134, v135
    v_cvt_pk_bf16_f32 v68, v136, v137
    v_cvt_pk_bf16_f32 v69, v138, v139
    v_cvt_pk_bf16_f32 v70, v140, v141
    v_cvt_pk_bf16_f32 v71, v142, v143
    buffer_store_dwordx4 v[64:67], v2, s[12:15], s37 offen offset:0 sc1
    buffer_store_dwordx4 v[68:71], v2, s[12:15], s37 offen offset:1024 sc1
    v_mul_f32 v144, v144, v11
    v_mul_f32 v145, v145, v11
    v_mul_f32 v146, v146, v11
    v_mul_f32 v147, v147, v11
    v_mul_f32 v148, v148, v11
    v_mul_f32 v149, v149, v11
    v_mul_f32 v150, v150, v11
    v_mul_f32 v151, v151, v11
    v_mul_f32 v152, v152, v11
    v_mul_f32 v153, v153, v11
    v_mul_f32 v154, v154, v11
    v_mul_f32 v155, v155, v11
    v_mul_f32 v156, v156, v11
    v_mul_f32 v157, v157, v11
    v_mul_f32 v158, v158, v11
    v_mul_f32 v159, v159, v11
    v_cvt_pk_bf16_f32 v72, v144, v145
    v_cvt_pk_bf16_f32 v73, v146, v147
    v_cvt_pk_bf16_f32 v74, v148, v149
    v_cvt_pk_bf16_f32 v75, v150, v151
    v_cvt_pk_bf16_f32 v76, v152, v153
    v_cvt_pk_bf16_f32 v77, v154, v155
    v_cvt_pk_bf16_f32 v78, v156, v157
    v_cvt_pk_bf16_f32 v79, v158, v159
    buffer_store_dwordx4 v[72:75], v2, s[12:15], s37 offen offset:2048 sc1
    buffer_store_dwordx4 v[76:79], v2, s[12:15], s37 offen offset:3072 sc1
    v_mul_f32 v160, v160, v11
    v_mul_f32 v161, v161, v11
    v_mul_f32 v162, v162, v11
    v_mul_f32 v163, v163, v11
    v_mul_f32 v164, v164, v11
    v_mul_f32 v165, v165, v11
    v_mul_f32 v166, v166, v11
    v_mul_f32 v167, v167, v11
    v_mul_f32 v168, v168, v11
    v_mul_f32 v169, v169, v11
    v_mul_f32 v170, v170, v11
    v_mul_f32 v171, v171, v11
    v_mul_f32 v172, v172, v11
    v_mul_f32 v173, v173, v11
    v_mul_f32 v174, v174, v11
    v_mul_f32 v175, v175, v11
    v_cvt_pk_bf16_f32 v80, v160, v161
    v_cvt_pk_bf16_f32 v81, v162, v163
    v_cvt_pk_bf16_f32 v82, v164, v165
    v_cvt_pk_bf16_f32 v83, v166, v167
    v_cvt_pk_bf16_f32 v84, v168, v169
    v_cvt_pk_bf16_f32 v85, v170, v171
    v_cvt_pk_bf16_f32 v86, v172, v173
    v_cvt_pk_bf16_f32 v87, v174, v175
    buffer_store_dwordx4 v[80:83], v2, s[12:15], s42 offen offset:0 sc1
    buffer_store_dwordx4 v[84:87], v2, s[12:15], s42 offen offset:1024 sc1
    v_mul_f32 v176, v176, v11
    v_mul_f32 v177, v177, v11
    v_mul_f32 v178, v178, v11
    v_mul_f32 v179, v179, v11
    v_mul_f32 v180, v180, v11
    v_mul_f32 v181, v181, v11
    v_mul_f32 v182, v182, v11
    v_mul_f32 v183, v183, v11
    v_mul_f32 v184, v184, v11
    v_mul_f32 v185, v185, v11
    v_mul_f32 v186, v186, v11
    v_mul_f32 v187, v187, v11
    v_mul_f32 v188, v188, v11
    v_mul_f32 v189, v189, v11
    v_mul_f32 v190, v190, v11
    v_mul_f32 v191, v191, v11
    v_cvt_pk_bf16_f32 v88, v176, v177
    v_cvt_pk_bf16_f32 v89, v178, v179
    v_cvt_pk_bf16_f32 v90, v180, v181
    v_cvt_pk_bf16_f32 v91, v182, v183
    v_cvt_pk_bf16_f32 v92, v184, v185
    v_cvt_pk_bf16_f32 v93, v186, v187
    v_cvt_pk_bf16_f32 v94, v188, v189
    v_cvt_pk_bf16_f32 v95, v190, v191
    buffer_store_dwordx4 v[88:91], v2, s[12:15], s42 offen offset:2048 sc1
    buffer_store_dwordx4 v[92:95], v2, s[12:15], s42 offen offset:3072 sc1
    s_mov_b32 s90, s62
    s_mov_b32 s91, s63
    s_load_dwordx2 s[4:5], s[0:1], 32
    s_load_dwordx4 s[40:43], s[0:1], 48
    s_load_dwordx4 s[44:47], s[0:1], 64
    s_load_dwordx2 s[48:49], s[0:1], 0
    s_load_dwordx2 s[50:51], s[0:1], 80
    v_and_b32 v1, 63, v0
    v_lshlrev_b32 v2, 4, v1
    s_lshl_b32 s26, s3, 11
    s_lshl_b32 s27, s3, 10
    s_add_u32 s27, s27, 16384
    s_mov_b32 s24, 0
    s_mov_b32 s25, 0
    s_and_b32 s31, s3, 3
    s_lshr_b32 s32, s3, 2
    s_lshr_b32 s33, s2, 4
    s_and_b32 s34, s2, 7
    v_lshrrev_b32 v7, 5, v1
    v_lshlrev_b32 v7, 10, v7
    v_bfe_u32 v5, v1, 2, 2
    v_lshl_add_u32 v7, v5, 8, v7
    v_xor_b32 v5, s31, v5
    v_lshl_add_u32 v7, v5, 6, v7
    v_bfe_u32 v5, v1, 4, 1
    v_lshlrev_b32 v6, 5, v5
    v_and_b32 v5, 3, v1
    v_lshl_add_u32 v6, v5, 3, v6
    v_add_u32 v7, v7, v6
    s_lshl_b32 s28, s32, 12
    s_add_u32 s28, s28, 16384
    v_add_u32 v8, s28, v2
    v_lshrrev_b32 v9, 5, v1
    v_lshlrev_b32 v9, 9, v9
    v_bfe_u32 v5, v1, 2, 2
    v_lshl_add_u32 v9, v5, 7, v9
    v_bfe_u32 v5, v1, 3, 1
    v_xor_b32 v5, s32, v5
    v_lshl_add_u32 v9, v5, 6, v9
    v_add_u32 v9, v9, v6
    v_add_u32 v9, 0x4000, v9
    v_lshl_add_u32 v10, s31, 12, v2
    v_mov_b32 v24, 0
    v_mov_b32 v40, 0
    v_mov_b32 v25, 0
    v_mov_b32 v41, 0
    v_mov_b32 v26, 0
    v_mov_b32 v42, 0
    v_mov_b32 v27, 0
    v_mov_b32 v43, 0
    v_mov_b32 v28, 0
    v_mov_b32 v44, 0
    v_mov_b32 v29, 0
    v_mov_b32 v45, 0
    v_mov_b32 v30, 0
    v_mov_b32 v46, 0
    v_mov_b32 v31, 0
    v_mov_b32 v47, 0
    v_mov_b32 v32, 0
    v_mov_b32 v48, 0
    v_mov_b32 v33, 0
    v_mov_b32 v49, 0
    v_mov_b32 v34, 0
    v_mov_b32 v50, 0
    v_mov_b32 v35, 0
    v_mov_b32 v51, 0
    v_mov_b32 v36, 0
    v_mov_b32 v52, 0
    v_mov_b32 v37, 0
    v_mov_b32 v53, 0
    v_mov_b32 v38, 0
    v_mov_b32 v54, 0
    v_mov_b32 v39, 0
    v_mov_b32 v55, 0
    v_and_b32 v15, 31, v1
    v_lshrrev_b32 v16, 5, v1
    v_lshlrev_b32 v16, 3, v16
    s_and_b32 s39, s3, 3
    s_lshl_b32 s39, s39, 10
    s_and_b32 s36, s33, 3
    s_lshl2_add_u32 s36, s34, s36
    s_lshr_b32 s37, s33, 2
    s_lshl1_add_u32 s82, s36, s32
    s_lshl2_add_u32 s83, s37, s31
    s_lshl_b32 s84, s3, 13
    s_lshl_b32 s38, s37, 8
    s_add_u32 s84, s84, s38
    s_lshl_b32 s85, s82, 18
    s_add_u32 s85, s85, s39
    s_add_u32 s85, s85, 4194304
    s_lshl3_add_u32 s87, s33, s34
    s_lshl_b32 s87, s87, 15
    s_lshl_b32 s38, s3, 12
    s_add_u32 s87, s87, s38
    s_add_u32 s87, s87, 27262976
    s_lshl_b32 s38, s34, 12
    s_add_u32 s38, s38, 25165824
    v_lshl_add_u32 v17, v15, 7, s38
    s_bfe_u32 s35, s2, 0x10003
    s_waitcnt lgkmcnt(0)
    s_mov_b32 s8, s4
    s_and_b32 s9, s5, 0xffff
    s_mov_b32 s10, 0x400000
    s_mov_b32 s11, 0x20000
    v_lshrrev_b32 v5, 4, v1
    v_and_b32 v6, 15, v1
    v_lshlrev_b32 v13, 2, v5
    v_xor_b32 v13, v13, v6
    v_lshlrev_b32 v13, 4, v13
    s_mov_b32 s28, 1024
    v_mad_u32_u24 v13, v5, s28, v13
    v_add_u32 v14, 3072, v13
    s_cmp_eq_u32 s35, 0
    s_cbranch_scc1 L_roleB
    s_mov_b32 s16, s40
    s_and_b32 s17, s41, 0xffff
    s_mov_b32 s18, 0x700000
    s_mov_b32 s19, 0x20000
    s_mov_b32 s40, s42
    s_and_b32 s41, s43, 0xffff
    s_mov_b32 s42, 0xe00
    s_mov_b32 s43, 0x20000
    v_lshrrev_b32 v5, 4, v1
    v_and_b32 v6, 15, v1
    v_lshlrev_b32 v11, 2, v5
    v_xor_b32 v11, v11, v6
    v_lshlrev_b32 v11, 4, v11
    s_mov_b32 s28, 3584
    v_mad_u32_u24 v11, v5, s28, v11
    v_add_u32 v12, 13312, v11
    s_add_u32 s84, s84, 2097152
    s_add_u32 s85, s85, 131072
    s_mul_i32 s38, s33, 37
    s_lshr_b32 s38, s38, 8
    s_mul_i32 s88, s38, 7
    s_sub_u32 s86, s33, s88
    s_lshr_b32 s88, s34, 2
    s_mul_i32 s88, s88, 7
    s_add_u32 s86, s86, s88
    s_and_b32 s88, s34, 3
    s_lshl1_add_u32 s88, s88, s38
    s_lshl2_add_u32 s89, s86, s31
    s_lshl_b32 s38, s89, 6
    buffer_load_dwordx2 v[104:105], v16, s[40:43], s38 offen offset:0
    buffer_load_dwordx2 v[106:107], v16, s[40:43], s38 offen offset:16
    buffer_load_dwordx2 v[108:109], v16, s[40:43], s38 offen offset:32
    buffer_load_dwordx2 v[110:111], v16, s[40:43], s38 offen offset:48
    s_cmp_ge_u32 s33, 14
    s_cbranch_scc1 L_nou
    s_mov_b32 s80, s90
    s_mov_b32 s81, s91
    s_mov_b32 s24, 98304
    s_barrier
    s_add_u32 m0, s24, s26
    s_add_u32 s28, s24, s27
    buffer_load_dwordx4 v11, s[16:19], s80 offen lds
    buffer_load_dwordx4 v12, s[16:19], s80 offen offset:1024 lds
    s_mov_b32 m0, s28
    s_add_u32 s80, s80, 229376
    buffer_load_dwordx4 v2, s[12:15], s81 offen lds
    s_add_u32 s81, s81, 4096
    s_add_u32 s24, s24, 24576
    s_cmp_eq_u32 s24, 147456
    s_cselect_b32 s24, 0, s24
    s_mov_b32 s30, 4
L_u_0:
    s_waitcnt vmcnt(24)
    s_barrier
    v_add_u32 v3, s25, v7
    v_add_u32 v4, s25, v8
    ds_read_b64_tr_b16 v[56:57], v3 offset:0
    ds_read_b64_tr_b16 v[58:59], v3 offset:2048
    ds_read_b128 v[72:75], v4 offset:0
    ds_read_b64_tr_b16 v[60:61], v3 offset:4096
    ds_read_b64_tr_b16 v[62:63], v3 offset:6144
    ds_read_b128 v[76:79], v4 offset:1024
    ds_read_b64_tr_b16 v[64:65], v3 offset:8192
    ds_read_b64_tr_b16 v[66:67], v3 offset:10240
    ds_read_b128 v[80:83], v4 offset:2048
    ds_read_b64_tr_b16 v[68:69], v3 offset:12288
    ds_read_b64_tr_b16 v[70:71], v3 offset:14336
    ds_read_b128 v[84:87], v4 offset:3072
    s_add_u32 s25, s25, 24576
    s_cmp_eq_u32 s25, 147456
    s_cselect_b32 s25, 0, s25
    s_waitcnt lgkmcnt(9)
    v_mfma_f32_32x32x16_bf16 v[40:55], v[56:59], v[72:75], v[40:55]
    s_waitcnt lgkmcnt(6)
    v_mfma_f32_32x32x16_bf16 v[40:55], v[60:63], v[76:79], v[40:55]
    s_waitcnt lgkmcnt(3)
    v_mfma_f32_32x32x16_bf16 v[40:55], v[64:67], v[80:83], v[40:55]
    s_waitcnt lgkmcnt(0)
    v_mfma_f32_32x32x16_bf16 v[40:55], v[68:71], v[84:87], v[40:55]
    s_add_u32 m0, s24, s26
    s_add_u32 s28, s24, s27
    buffer_load_dwordx4 v11, s[16:19], s80 offen lds
    buffer_load_dwordx4 v12, s[16:19], s80 offen offset:1024 lds
    s_mov_b32 m0, s28
    s_add_u32 s80, s80, 229376
    buffer_load_dwordx4 v2, s[12:15], s81 offen lds
    s_add_u32 s81, s81, 4096
    s_add_u32 s24, s24, 24576
    s_cmp_eq_u32 s24, 147456
    s_cselect_b32 s24, 0, s24
    s_sub_u32 s30, s30, 1
    s_cmp_lg_u32 s30, 0
    s_cbranch_scc1 L_u_0
    s_waitcnt vmcnt(12)
    s_barrier
    v_add_u32 v3, s25, v7
    v_add_u32 v4, s25, v8
    ds_read_b64_tr_b16 v[56:57], v3 offset:0
    ds_read_b64_tr_b16 v[58:59], v3 offset:2048
    ds_read_b128 v[72:75], v4 offset:0
    ds_read_b64_tr_b16 v[60:61], v3 offset:4096
    ds_read_b64_tr_b16 v[62:63], v3 offset:6144
    ds_read_b128 v[76:79], v4 offset:1024
    ds_read_b64_tr_b16 v[64:65], v3 offset:8192
    ds_read_b64_tr_b16 v[66:67], v3 offset:10240
    ds_read_b128 v[80:83], v4 offset:2048
    ds_read_b64_tr_b16 v[68:69], v3 offset:12288
    ds_read_b64_tr_b16 v[70:71], v3 offset:14336
    ds_read_b128 v[84:87], v4 offset:3072
    s_add_u32 s25, s25, 24576
    s_cmp_eq_u32 s25, 147456
    s_cselect_b32 s25, 0, s25
    s_waitcnt lgkmcnt(9)
    v_mfma_f32_32x32x16_bf16 v[40:55], v[56:59], v[72:75], v[40:55]
    s_waitcnt lgkmcnt(6)
    v_mfma_f32_32x32x16_bf16 v[40:55], v[60:63], v[76:79], v[40:55]
    s_waitcnt lgkmcnt(3)
    v_mfma_f32_32x32x16_bf16 v[40:55], v[64:67], v[80:83], v[40:55]
    s_waitcnt lgkmcnt(0)
    v_mfma_f32_32x32x16_bf16 v[40:55], v[68:71], v[84:87], v[40:55]
    s_add_u32 m0, s24, s26
    s_add_u32 s28, s24, s27
    buffer_load_dwordx4 v11, s[16:19], s80 offen lds
    buffer_load_dwordx4 v12, s[16:19], s80 offen offset:1024 lds
    s_mov_b32 m0, s28
    s_add_u32 s80, s80, 229376
    buffer_load_dwordx4 v2, s[12:15], s81 offen lds
    s_add_u32 s81, s81, 4096
    s_add_u32 s24, s24, 24576
    s_cmp_eq_u32 s24, 147456
    s_cselect_b32 s24, 0, s24
    s_cmp_lg_u32 s3, 0
    s_cbranch_scc1 L_w0_osig
    s_lshl_b32 s95, s2, 7
    s_add_u32 s95, s95, 25165824
    s_mov_b64 exec, 1
    v_mov_b32 v22, 1
    v_mov_b32 v23, 0
    buffer_store_dword v22, v23, s[12:15], s95 offen sc1
    s_mov_b64 exec, -1
L_w0_osig:
    s_mov_b32 s30, 17
L_u_1:
    s_waitcnt vmcnt(12)
    s_barrier
    v_add_u32 v3, s25, v7
    v_add_u32 v4, s25, v8
    ds_read_b64_tr_b16 v[56:57], v3 offset:0
    ds_read_b64_tr_b16 v[58:59], v3 offset:2048
    ds_read_b128 v[72:75], v4 offset:0
    ds_read_b64_tr_b16 v[60:61], v3 offset:4096
    ds_read_b64_tr_b16 v[62:63], v3 offset:6144
    ds_read_b128 v[76:79], v4 offset:1024
    ds_read_b64_tr_b16 v[64:65], v3 offset:8192
    ds_read_b64_tr_b16 v[66:67], v3 offset:10240
    ds_read_b128 v[80:83], v4 offset:2048
    ds_read_b64_tr_b16 v[68:69], v3 offset:12288
    ds_read_b64_tr_b16 v[70:71], v3 offset:14336
    ds_read_b128 v[84:87], v4 offset:3072
    s_add_u32 s25, s25, 24576
    s_cmp_eq_u32 s25, 147456
    s_cselect_b32 s25, 0, s25
    s_waitcnt lgkmcnt(9)
    v_mfma_f32_32x32x16_bf16 v[40:55], v[56:59], v[72:75], v[40:55]
    s_waitcnt lgkmcnt(6)
    v_mfma_f32_32x32x16_bf16 v[40:55], v[60:63], v[76:79], v[40:55]
    s_waitcnt lgkmcnt(3)
    v_mfma_f32_32x32x16_bf16 v[40:55], v[64:67], v[80:83], v[40:55]
    s_waitcnt lgkmcnt(0)
    v_mfma_f32_32x32x16_bf16 v[40:55], v[68:71], v[84:87], v[40:55]
    s_add_u32 m0, s24, s26
    s_add_u32 s28, s24, s27
    buffer_load_dwordx4 v11, s[16:19], s80 offen lds
    buffer_load_dwordx4 v12, s[16:19], s80 offen offset:1024 lds
    s_mov_b32 m0, s28
    s_add_u32 s80, s80, 229376
    buffer_load_dwordx4 v2, s[12:15], s81 offen lds
    s_add_u32 s81, s81, 4096
    s_add_u32 s24, s24, 24576
    s_cmp_eq_u32 s24, 147456
    s_cselect_b32 s24, 0, s24
    s_sub_u32 s30, s30, 1
    s_cmp_lg_u32 s30, 0
    s_cbranch_scc1 L_u_1
    s_cmp_lg_u32 s3, 0
    s_cbranch_scc1 L_w0_osmp
    buffer_load_dword v19, v17, s[12:15], 0 offen sc1
L_w0_osmp:
    s_mov_b32 s30, 5
L_u_1b:
    s_waitcnt vmcnt(12)
    s_barrier
    v_add_u32 v3, s25, v7
    v_add_u32 v4, s25, v8
    ds_read_b64_tr_b16 v[56:57], v3 offset:0
    ds_read_b64_tr_b16 v[58:59], v3 offset:2048
    ds_read_b128 v[72:75], v4 offset:0
    ds_read_b64_tr_b16 v[60:61], v3 offset:4096
    ds_read_b64_tr_b16 v[62:63], v3 offset:6144
    ds_read_b128 v[76:79], v4 offset:1024
    ds_read_b64_tr_b16 v[64:65], v3 offset:8192
    ds_read_b64_tr_b16 v[66:67], v3 offset:10240
    ds_read_b128 v[80:83], v4 offset:2048
    ds_read_b64_tr_b16 v[68:69], v3 offset:12288
    ds_read_b64_tr_b16 v[70:71], v3 offset:14336
    ds_read_b128 v[84:87], v4 offset:3072
    s_add_u32 s25, s25, 24576
    s_cmp_eq_u32 s25, 147456
    s_cselect_b32 s25, 0, s25
    s_waitcnt lgkmcnt(9)
    v_mfma_f32_32x32x16_bf16 v[40:55], v[56:59], v[72:75], v[40:55]
    s_waitcnt lgkmcnt(6)
    v_mfma_f32_32x32x16_bf16 v[40:55], v[60:63], v[76:79], v[40:55]
    s_waitcnt lgkmcnt(3)
    v_mfma_f32_32x32x16_bf16 v[40:55], v[64:67], v[80:83], v[40:55]
    s_waitcnt lgkmcnt(0)
    v_mfma_f32_32x32x16_bf16 v[40:55], v[68:71], v[84:87], v[40:55]
    s_add_u32 m0, s24, s26
    s_add_u32 s28, s24, s27
    buffer_load_dwordx4 v11, s[16:19], s80 offen lds
    buffer_load_dwordx4 v12, s[16:19], s80 offen offset:1024 lds
    s_mov_b32 m0, s28
    s_add_u32 s80, s80, 229376
    buffer_load_dwordx4 v2, s[12:15], s81 offen lds
    s_add_u32 s81, s81, 4096
    s_add_u32 s24, s24, 24576
    s_cmp_eq_u32 s24, 147456
    s_cselect_b32 s24, 0, s24
    s_sub_u32 s30, s30, 1
    s_cmp_lg_u32 s30, 0
    s_cbranch_scc1 L_u_1b
    s_cmp_lg_u32 s3, 0
    s_cbranch_scc1 L_w0_opoll
    s_mov_b32 s94, 300000
    s_branch L_pchk_o
L_poll_o:
    buffer_load_dword v19, v17, s[12:15], 0 offen sc1
    s_waitcnt vmcnt(0)
L_pchk_o:
    v_cmp_ne_u32 vcc, 1, v19
    s_sub_u32 s94, s94, 1
    s_cbranch_vccz L_pdone_o
    s_cmp_eq_u32 s94, 0
    s_cbranch_scc1 L_pdone_o
    s_sleep 8
    s_branch L_poll_o
L_pdone_o:
L_w0_opoll:
    s_mov_b32 s30, 5
L_u_2:
    s_waitcnt vmcnt(12)
    s_barrier
    v_add_u32 v3, s25, v7
    v_add_u32 v4, s25, v8
    ds_read_b64_tr_b16 v[56:57], v3 offset:0
    ds_read_b64_tr_b16 v[58:59], v3 offset:2048
    ds_read_b128 v[72:75], v4 offset:0
    ds_read_b64_tr_b16 v[60:61], v3 offset:4096
    ds_read_b64_tr_b16 v[62:63], v3 offset:6144
    ds_read_b128 v[76:79], v4 offset:1024
    ds_read_b64_tr_b16 v[64:65], v3 offset:8192
    ds_read_b64_tr_b16 v[66:67], v3 offset:10240
    ds_read_b128 v[80:83], v4 offset:2048
    ds_read_b64_tr_b16 v[68:69], v3 offset:12288
    ds_read_b64_tr_b16 v[70:71], v3 offset:14336
    ds_read_b128 v[84:87], v4 offset:3072
    s_add_u32 s25, s25, 24576
    s_cmp_eq_u32 s25, 147456
    s_cselect_b32 s25, 0, s25
    s_waitcnt lgkmcnt(9)
    v_mfma_f32_32x32x16_bf16 v[40:55], v[56:59], v[72:75], v[40:55]
    s_waitcnt lgkmcnt(6)
    v_mfma_f32_32x32x16_bf16 v[40:55], v[60:63], v[76:79], v[40:55]
    s_waitcnt lgkmcnt(3)
    v_mfma_f32_32x32x16_bf16 v[40:55], v[64:67], v[80:83], v[40:55]
    s_waitcnt lgkmcnt(0)
    v_mfma_f32_32x32x16_bf16 v[40:55], v[68:71], v[84:87], v[40:55]
    s_add_u32 m0, s24, s26
    s_add_u32 s28, s24, s27
    buffer_load_dwordx4 v13, s[8:11], s84 offen lds
    buffer_load_dwordx4 v14, s[8:11], s84 offen offset:1024 lds
    s_mov_b32 m0, s28
    s_add_u32 s84, s84, 65536
    buffer_load_dwordx4 v2, s[12:15], s85 offen lds
    s_add_u32 s85, s85, 4096
    s_add_u32 s24, s24, 24576
    s_cmp_eq_u32 s24, 147456
    s_cselect_b32 s24, 0, s24
    s_sub_u32 s30, s30, 1
    s_cmp_lg_u32 s30, 0
    s_cbranch_scc1 L_u_2
    v_cvt_pk_bf16_f32 v56, v40, v41
    v_cvt_pk_bf16_f32 v57, v42, v43
    v_cvt_pk_bf16_f32 v58, v44, v45
    v_cvt_pk_bf16_f32 v59, v46, v47
    v_lshlrev_b32 v40, 16, v56
    v_and_b32 v41, 0xffff0000, v56
    v_lshlrev_b32 v42, 16, v57
    v_and_b32 v43, 0xffff0000, v57
    v_lshlrev_b32 v44, 16, v58
    v_and_b32 v45, 0xffff0000, v58
    v_lshlrev_b32 v46, 16, v59
    v_and_b32 v47, 0xffff0000, v59
    v_cvt_pk_bf16_f32 v60, v48, v49
    v_cvt_pk_bf16_f32 v61, v50, v51
    v_cvt_pk_bf16_f32 v62, v52, v53
    v_cvt_pk_bf16_f32 v63, v54, v55
    v_lshlrev_b32 v48, 16, v60
    v_and_b32 v49, 0xffff0000, v60
    v_lshlrev_b32 v50, 16, v61
    v_and_b32 v51, 0xffff0000, v61
    v_lshlrev_b32 v52, 16, v62
    v_and_b32 v53, 0xffff0000, v62
    v_lshlrev_b32 v54, 16, v63
    v_and_b32 v55, 0xffff0000, v63
    v_lshlrev_b32 v88, 16, v104
    v_and_b32 v89, 0xffff0000, v104
    v_lshlrev_b32 v90, 16, v105
    v_and_b32 v91, 0xffff0000, v105
    v_lshlrev_b32 v92, 16, v106
    v_and_b32 v93, 0xffff0000, v106
    v_lshlrev_b32 v94, 16, v107
    v_and_b32 v95, 0xffff0000, v107
    v_lshlrev_b32 v96, 16, v108
    v_and_b32 v97, 0xffff0000, v108
    v_lshlrev_b32 v98, 16, v109
    v_and_b32 v99, 0xffff0000, v109
    v_lshlrev_b32 v100, 16, v110
    v_and_b32 v101, 0xffff0000, v110
    v_lshlrev_b32 v102, 16, v111
    v_and_b32 v103, 0xffff0000, v111
    v_add_f32 v40, v40, v88
    v_add_f32 v41, v41, v89
    v_add_f32 v42, v42, v90
    v_add_f32 v43, v43, v91
    v_add_f32 v44, v44, v92
    v_add_f32 v45, v45, v93
    v_add_f32 v46, v46, v94
    v_add_f32 v47, v47, v95
    v_add_f32 v48, v48, v96
    v_add_f32 v49, v49, v97
    v_add_f32 v50, v50, v98
    v_add_f32 v51, v51, v99
    v_add_f32 v52, v52, v100
    v_add_f32 v53, v53, v101
    v_add_f32 v54, v54, v102
    v_add_f32 v55, v55, v103
    v_cvt_pk_bf16_f32 v56, v40, v41
    v_cvt_pk_bf16_f32 v57, v42, v43
    v_cvt_pk_bf16_f32 v58, v44, v45
    v_cvt_pk_bf16_f32 v59, v46, v47
    v_lshlrev_b32 v40, 16, v56
    v_and_b32 v41, 0xffff0000, v56
    v_lshlrev_b32 v42, 16, v57
    v_and_b32 v43, 0xffff0000, v57
    v_lshlrev_b32 v44, 16, v58
    v_and_b32 v45, 0xffff0000, v58
    v_lshlrev_b32 v46, 16, v59
    v_and_b32 v47, 0xffff0000, v59
    v_cvt_pk_bf16_f32 v60, v48, v49
    v_cvt_pk_bf16_f32 v61, v50, v51
    v_cvt_pk_bf16_f32 v62, v52, v53
    v_cvt_pk_bf16_f32 v63, v54, v55
    v_lshlrev_b32 v48, 16, v60
    v_and_b32 v49, 0xffff0000, v60
    v_lshlrev_b32 v50, 16, v61
    v_and_b32 v51, 0xffff0000, v61
    v_lshlrev_b32 v52, 16, v62
    v_and_b32 v53, 0xffff0000, v62
    v_lshlrev_b32 v54, 16, v63
    v_and_b32 v55, 0xffff0000, v63
    s_mov_b32 s39, 0xbdd2d3e8
    v_mov_b32 v5, 0xc0135761
    v_mul_f32 v88, v40, v40
    v_mul_f32 v89, v41, v41
    v_mul_f32 v90, v42, v42
    v_mul_f32 v91, v43, v43
    v_mul_f32 v92, v44, v44
    v_mul_f32 v93, v45, v45
    v_mul_f32 v94, v46, v46
    v_mul_f32 v95, v47, v47
    v_mul_f32 v96, v48, v48
    v_mul_f32 v97, v49, v49
    v_mul_f32 v98, v50, v50
    v_mul_f32 v99, v51, v51
    v_mul_f32 v100, v52, v52
    v_mul_f32 v101, v53, v53
    v_mul_f32 v102, v54, v54
    v_mul_f32 v103, v55, v55
    v_fma_f32 v88, v88, s39, v5
    v_fma_f32 v89, v89, s39, v5
    v_fma_f32 v90, v90, s39, v5
    v_fma_f32 v91, v91, s39, v5
    v_fma_f32 v92, v92, s39, v5
    v_fma_f32 v93, v93, s39, v5
    v_fma_f32 v94, v94, s39, v5
    v_fma_f32 v95, v95, s39, v5
    v_fma_f32 v96, v96, s39, v5
    v_fma_f32 v97, v97, s39, v5
    v_fma_f32 v98, v98, s39, v5
    v_fma_f32 v99, v99, s39, v5
    v_fma_f32 v100, v100, s39, v5
    v_fma_f32 v101, v101, s39, v5
    v_fma_f32 v102, v102, s39, v5
    v_fma_f32 v103, v103, s39, v5
    v_mul_f32 v88, v88, v40
    v_mul_f32 v89, v89, v41
    v_mul_f32 v90, v90, v42
    v_mul_f32 v91, v91, v43
    v_mul_f32 v92, v92, v44
    v_mul_f32 v93, v93, v45
    v_mul_f32 v94, v94, v46
    v_mul_f32 v95, v95, v47
    v_mul_f32 v96, v96, v48
    v_mul_f32 v97, v97, v49
    v_mul_f32 v98, v98, v50
    v_mul_f32 v99, v99, v51
    v_mul_f32 v100, v100, v52
    v_mul_f32 v101, v101, v53
    v_mul_f32 v102, v102, v54
    v_mul_f32 v103, v103, v55
    v_exp_f32 v88, v88
    v_exp_f32 v89, v89
    v_exp_f32 v90, v90
    v_exp_f32 v91, v91
    v_exp_f32 v92, v92
    v_exp_f32 v93, v93
    v_exp_f32 v94, v94
    v_exp_f32 v95, v95
    v_exp_f32 v96, v96
    v_exp_f32 v97, v97
    v_exp_f32 v98, v98
    v_exp_f32 v99, v99
    v_exp_f32 v100, v100
    v_exp_f32 v101, v101
    v_exp_f32 v102, v102
    v_exp_f32 v103, v103
    v_add_f32 v88, 1.0, v88
    v_add_f32 v89, 1.0, v89
    v_add_f32 v90, 1.0, v90
    v_add_f32 v91, 1.0, v91
    v_add_f32 v92, 1.0, v92
    v_add_f32 v93, 1.0, v93
    v_add_f32 v94, 1.0, v94
    v_add_f32 v95, 1.0, v95
    v_add_f32 v96, 1.0, v96
    v_add_f32 v97, 1.0, v97
    v_add_f32 v98, 1.0, v98
    v_add_f32 v99, 1.0, v99
    v_add_f32 v100, 1.0, v100
    v_add_f32 v101, 1.0, v101
    v_add_f32 v102, 1.0, v102
    v_add_f32 v103, 1.0, v103
    v_rcp_f32 v88, v88
    v_rcp_f32 v89, v89
    v_rcp_f32 v90, v90
    v_rcp_f32 v91, v91
    v_rcp_f32 v92, v92
    v_rcp_f32 v93, v93
    v_rcp_f32 v94, v94
    v_rcp_f32 v95, v95
    v_rcp_f32 v96, v96
    v_rcp_f32 v97, v97
    v_rcp_f32 v98, v98
    v_rcp_f32 v99, v99
    v_rcp_f32 v100, v100
    v_rcp_f32 v101, v101
    v_rcp_f32 v102, v102
    v_rcp_f32 v103, v103
    v_mul_f32 v40, v40, v88
    v_mul_f32 v41, v41, v89
    v_mul_f32 v42, v42, v90
    v_mul_f32 v43, v43, v91
    v_mul_f32 v44, v44, v92
    v_mul_f32 v45, v45, v93
    v_mul_f32 v46, v46, v94
    v_mul_f32 v47, v47, v95
    v_mul_f32 v48, v48, v96
    v_mul_f32 v49, v49, v97
    v_mul_f32 v50, v50, v98
    v_mul_f32 v51, v51, v99
    v_mul_f32 v52, v52, v100
    v_mul_f32 v53, v53, v101
    v_mul_f32 v54, v54, v102
    v_mul_f32 v55, v55, v103
    v_cvt_pk_bf16_f32 v88, v40, v41
    v_cvt_pk_bf16_f32 v89, v42, v43
    v_cvt_pk_bf16_f32 v90, v44, v45
    v_cvt_pk_bf16_f32 v91, v46, v47
    v_cvt_pk_bf16_f32 v92, v48, v49
    v_cvt_pk_bf16_f32 v93, v50, v51
    v_cvt_pk_bf16_f32 v94, v52, v53
    v_cvt_pk_bf16_f32 v95, v54, v55
    s_lshl1_add_u32 s38, s88, s32
    s_mul_i32 s38, s38, 112
    s_lshl1_add_u32 s38, s89, s38
    s_lshl_b32 s38, s38, 10
    s_add_u32 s38, s38, 20971520
    buffer_store_dwordx4 v[88:91], v2, s[12:15], s38 offen sc1
    buffer_store_dwordx4 v[92:95], v2, s[12:15], s38 offen offset:1024 sc1
    s_waitcnt vmcnt(0)
    s_barrier
    s_cmp_lg_u32 s3, 0
    s_cbranch_scc1 L_w0_usig
    s_lshl_b32 s95, s2, 7
    s_add_u32 s95, s95, 25198592
    s_mov_b64 exec, 1
    v_mov_b32 v22, 1
    v_mov_b32 v23, 0
    buffer_store_dword v22, v23, s[12:15], s95 offen sc1
    s_mov_b64 exec, -1
L_w0_usig:
    s_mov_b32 s30, 5
L_ga_0:
    s_waitcnt vmcnt(12)
    s_barrier
    v_add_u32 v3, s25, v7
    v_add_u32 v4, s25, v8
    ds_read_b64_tr_b16 v[56:57], v3 offset:0
    ds_read_b64_tr_b16 v[58:59], v3 offset:2048
    ds_read_b128 v[72:75], v4 offset:0
    ds_read_b64_tr_b16 v[60:61], v3 offset:4096
    ds_read_b64_tr_b16 v[62:63], v3 offset:6144
    ds_read_b128 v[76:79], v4 offset:1024
    ds_read_b64_tr_b16 v[64:65], v3 offset:8192
    ds_read_b64_tr_b16 v[66:67], v3 offset:10240
    ds_read_b128 v[80:83], v4 offset:2048
    ds_read_b64_tr_b16 v[68:69], v3 offset:12288
    ds_read_b64_tr_b16 v[70:71], v3 offset:14336
    ds_read_b128 v[84:87], v4 offset:3072
    s_add_u32 s25, s25, 24576
    s_cmp_eq_u32 s25, 147456
    s_cselect_b32 s25, 0, s25
    s_waitcnt lgkmcnt(9)
    v_mfma_f32_32x32x16_bf16 v[24:39], v[56:59], v[72:75], v[24:39]
    s_waitcnt lgkmcnt(6)
    v_mfma_f32_32x32x16_bf16 v[24:39], v[60:63], v[76:79], v[24:39]
    s_waitcnt lgkmcnt(3)
    v_mfma_f32_32x32x16_bf16 v[24:39], v[64:67], v[80:83], v[24:39]
    s_waitcnt lgkmcnt(0)
    v_mfma_f32_32x32x16_bf16 v[24:39], v[68:71], v[84:87], v[24:39]
    s_add_u32 m0, s24, s26
    s_add_u32 s28, s24, s27
    buffer_load_dwordx4 v13, s[8:11], s84 offen lds
    buffer_load_dwordx4 v14, s[8:11], s84 offen offset:1024 lds
    s_mov_b32 m0, s28
    s_add_u32 s84, s84, 65536
    buffer_load_dwordx4 v2, s[12:15], s85 offen lds
    s_add_u32 s85, s85, 4096
    s_add_u32 s24, s24, 24576
    s_cmp_eq_u32 s24, 147456
    s_cselect_b32 s24, 0, s24
    s_sub_u32 s30, s30, 1
    s_cmp_lg_u32 s30, 0
    s_cbranch_scc1 L_ga_0
    s_branch L_ga
L_nou:
    s_waitcnt vmcnt(0)
    s_barrier
    s_cmp_lg_u32 s3, 0
    s_cbranch_scc1 L_w0_o2
    s_lshl_b32 s95, s2, 7
    s_add_u32 s95, s95, 25165824
    s_mov_b64 exec, 1
    v_mov_b32 v22, 1
    v_mov_b32 v23, 0
    buffer_store_dword v22, v23, s[12:15], s95 offen sc1
    s_mov_b64 exec, -1
    s_mov_b32 s94, 300000
L_poll_o2:
    buffer_load_dword v19, v17, s[12:15], 0 offen sc1
    s_waitcnt vmcnt(0)
L_pchk_o2:
    v_cmp_ne_u32 vcc, 1, v19
    s_sub_u32 s94, s94, 1
    s_cbranch_vccz L_pdone_o2
    s_cmp_eq_u32 s94, 0
    s_cbranch_scc1 L_pdone_o2
    s_sleep 8
    s_branch L_poll_o2
L_pdone_o2:
L_w0_o2:
    s_barrier
    s_add_u32 m0, s24, s26
    s_add_u32 s28, s24, s27
    buffer_load_dwordx4 v13, s[8:11], s84 offen lds
    buffer_load_dwordx4 v14, s[8:11], s84 offen offset:1024 lds
    s_mov_b32 m0, s28
    s_add_u32 s84, s84, 65536
    buffer_load_dwordx4 v2, s[12:15], s85 offen lds
    s_add_u32 s85, s85, 4096
    s_add_u32 s24, s24, 24576
    s_cmp_eq_u32 s24, 147456
    s_cselect_b32 s24, 0, s24
    s_add_u32 m0, s24, s26
    s_add_u32 s28, s24, s27
    buffer_load_dwordx4 v13, s[8:11], s84 offen lds
    buffer_load_dwordx4 v14, s[8:11], s84 offen offset:1024 lds
    s_mov_b32 m0, s28
    s_add_u32 s84, s84, 65536
    buffer_load_dwordx4 v2, s[12:15], s85 offen lds
    s_add_u32 s85, s85, 4096
    s_add_u32 s24, s24, 24576
    s_cmp_eq_u32 s24, 147456
    s_cselect_b32 s24, 0, s24
    s_add_u32 m0, s24, s26
    s_add_u32 s28, s24, s27
    buffer_load_dwordx4 v13, s[8:11], s84 offen lds
    buffer_load_dwordx4 v14, s[8:11], s84 offen offset:1024 lds
    s_mov_b32 m0, s28
    s_add_u32 s84, s84, 65536
    buffer_load_dwordx4 v2, s[12:15], s85 offen lds
    s_add_u32 s85, s85, 4096
    s_add_u32 s24, s24, 24576
    s_cmp_eq_u32 s24, 147456
    s_cselect_b32 s24, 0, s24
    s_add_u32 m0, s24, s26
    s_add_u32 s28, s24, s27
    buffer_load_dwordx4 v13, s[8:11], s84 offen lds
    buffer_load_dwordx4 v14, s[8:11], s84 offen offset:1024 lds
    s_mov_b32 m0, s28
    s_add_u32 s84, s84, 65536
    buffer_load_dwordx4 v2, s[12:15], s85 offen lds
    s_add_u32 s85, s85, 4096
    s_add_u32 s24, s24, 24576
    s_cmp_eq_u32 s24, 147456
    s_cselect_b32 s24, 0, s24
    s_add_u32 m0, s24, s26
    s_add_u32 s28, s24, s27
    buffer_load_dwordx4 v13, s[8:11], s84 offen lds
    buffer_load_dwordx4 v14, s[8:11], s84 offen offset:1024 lds
    s_mov_b32 m0, s28
    s_add_u32 s84, s84, 65536
    buffer_load_dwordx4 v2, s[12:15], s85 offen lds
    s_add_u32 s85, s85, 4096
    s_add_u32 s24, s24, 24576
    s_cmp_eq_u32 s24, 147456
    s_cselect_b32 s24, 0, s24
    s_mov_b32 s30, 5
L_ga_1:
    s_waitcnt vmcnt(12)
    s_barrier
    v_add_u32 v3, s25, v7
    v_add_u32 v4, s25, v8
    ds_read_b64_tr_b16 v[56:57], v3 offset:0
    ds_read_b64_tr_b16 v[58:59], v3 offset:2048
    ds_read_b128 v[72:75], v4 offset:0
    ds_read_b64_tr_b16 v[60:61], v3 offset:4096
    ds_read_b64_tr_b16 v[62:63], v3 offset:6144
    ds_read_b128 v[76:79], v4 offset:1024
    ds_read_b64_tr_b16 v[64:65], v3 offset:8192
    ds_read_b64_tr_b16 v[66:67], v3 offset:10240
    ds_read_b128 v[80:83], v4 offset:2048
    ds_read_b64_tr_b16 v[68:69], v3 offset:12288
    ds_read_b64_tr_b16 v[70:71], v3 offset:14336
    ds_read_b128 v[84:87], v4 offset:3072
    s_add_u32 s25, s25, 24576
    s_cmp_eq_u32 s25, 147456
    s_cselect_b32 s25, 0, s25
    s_waitcnt lgkmcnt(9)
    v_mfma_f32_32x32x16_bf16 v[24:39], v[56:59], v[72:75], v[24:39]
    s_waitcnt lgkmcnt(6)
    v_mfma_f32_32x32x16_bf16 v[24:39], v[60:63], v[76:79], v[24:39]
    s_waitcnt lgkmcnt(3)
    v_mfma_f32_32x32x16_bf16 v[24:39], v[64:67], v[80:83], v[24:39]
    s_waitcnt lgkmcnt(0)
    v_mfma_f32_32x32x16_bf16 v[24:39], v[68:71], v[84:87], v[24:39]
    s_add_u32 m0, s24, s26
    s_add_u32 s28, s24, s27
    buffer_load_dwordx4 v13, s[8:11], s84 offen lds
    buffer_load_dwordx4 v14, s[8:11], s84 offen offset:1024 lds
    s_mov_b32 m0, s28
    s_add_u32 s84, s84, 65536
    buffer_load_dwordx4 v2, s[12:15], s85 offen lds
    s_add_u32 s85, s85, 4096
    s_add_u32 s24, s24, 24576
    s_cmp_eq_u32 s24, 147456
    s_cselect_b32 s24, 0, s24
    s_sub_u32 s30, s30, 1
    s_cmp_lg_u32 s30, 0
    s_cbranch_scc1 L_ga_1
L_ga:
    s_mov_b32 s30, 22
L_ga_2:
    s_waitcnt vmcnt(12)
    s_barrier
    v_add_u32 v3, s25, v7
    v_add_u32 v4, s25, v8
    ds_read_b64_tr_b16 v[56:57], v3 offset:0
    ds_read_b64_tr_b16 v[58:59], v3 offset:2048
    ds_read_b128 v[72:75], v4 offset:0
    ds_read_b64_tr_b16 v[60:61], v3 offset:4096
    ds_read_b64_tr_b16 v[62:63], v3 offset:6144
    ds_read_b128 v[76:79], v4 offset:1024
    ds_read_b64_tr_b16 v[64:65], v3 offset:8192
    ds_read_b64_tr_b16 v[66:67], v3 offset:10240
    ds_read_b128 v[80:83], v4 offset:2048
    ds_read_b64_tr_b16 v[68:69], v3 offset:12288
    ds_read_b64_tr_b16 v[70:71], v3 offset:14336
    ds_read_b128 v[84:87], v4 offset:3072
    s_add_u32 s25, s25, 24576
    s_cmp_eq_u32 s25, 147456
    s_cselect_b32 s25, 0, s25
    s_waitcnt lgkmcnt(9)
    v_mfma_f32_32x32x16_bf16 v[24:39], v[56:59], v[72:75], v[24:39]
    s_waitcnt lgkmcnt(6)
    v_mfma_f32_32x32x16_bf16 v[24:39], v[60:63], v[76:79], v[24:39]
    s_waitcnt lgkmcnt(3)
    v_mfma_f32_32x32x16_bf16 v[24:39], v[64:67], v[80:83], v[24:39]
    s_waitcnt lgkmcnt(0)
    v_mfma_f32_32x32x16_bf16 v[24:39], v[68:71], v[84:87], v[24:39]
    s_add_u32 m0, s24, s26
    s_add_u32 s28, s24, s27
    buffer_load_dwordx4 v13, s[8:11], s84 offen lds
    buffer_load_dwordx4 v14, s[8:11], s84 offen offset:1024 lds
    s_mov_b32 m0, s28
    s_add_u32 s84, s84, 65536
    buffer_load_dwordx4 v2, s[12:15], s85 offen lds
    s_add_u32 s85, s85, 4096
    s_add_u32 s24, s24, 24576
    s_cmp_eq_u32 s24, 147456
    s_cselect_b32 s24, 0, s24
    s_sub_u32 s30, s30, 1
    s_cmp_lg_u32 s30, 0
    s_cbranch_scc1 L_ga_2
    s_waitcnt vmcnt(12)
    s_barrier
    v_add_u32 v3, s25, v7
    v_add_u32 v4, s25, v8
    ds_read_b64_tr_b16 v[56:57], v3 offset:0
    ds_read_b64_tr_b16 v[58:59], v3 offset:2048
    ds_read_b128 v[72:75], v4 offset:0
    ds_read_b64_tr_b16 v[60:61], v3 offset:4096
    ds_read_b64_tr_b16 v[62:63], v3 offset:6144
    ds_read_b128 v[76:79], v4 offset:1024
    ds_read_b64_tr_b16 v[64:65], v3 offset:8192
    ds_read_b64_tr_b16 v[66:67], v3 offset:10240
    ds_read_b128 v[80:83], v4 offset:2048
    ds_read_b64_tr_b16 v[68:69], v3 offset:12288
    ds_read_b64_tr_b16 v[70:71], v3 offset:14336
    ds_read_b128 v[84:87], v4 offset:3072
    s_add_u32 s25, s25, 24576
    s_cmp_eq_u32 s25, 147456
    s_cselect_b32 s25, 0, s25
    s_waitcnt lgkmcnt(9)
    v_mfma_f32_32x32x16_bf16 v[24:39], v[56:59], v[72:75], v[24:39]
    s_waitcnt lgkmcnt(6)
    v_mfma_f32_32x32x16_bf16 v[24:39], v[60:63], v[76:79], v[24:39]
    s_waitcnt lgkmcnt(3)
    v_mfma_f32_32x32x16_bf16 v[24:39], v[64:67], v[80:83], v[24:39]
    s_waitcnt lgkmcnt(0)
    v_mfma_f32_32x32x16_bf16 v[24:39], v[68:71], v[84:87], v[24:39]
    s_waitcnt vmcnt(9)
    s_barrier
    v_add_u32 v3, s25, v7
    v_add_u32 v4, s25, v8
    ds_read_b64_tr_b16 v[56:57], v3 offset:0
    ds_read_b64_tr_b16 v[58:59], v3 offset:2048
    ds_read_b128 v[72:75], v4 offset:0
    ds_read_b64_tr_b16 v[60:61], v3 offset:4096
    ds_read_b64_tr_b16 v[62:63], v3 offset:6144
    ds_read_b128 v[76:79], v4 offset:1024
    ds_read_b64_tr_b16 v[64:65], v3 offset:8192
    ds_read_b64_tr_b16 v[66:67], v3 offset:10240
    ds_read_b128 v[80:83], v4 offset:2048
    ds_read_b64_tr_b16 v[68:69], v3 offset:12288
    ds_read_b64_tr_b16 v[70:71], v3 offset:14336
    ds_read_b128 v[84:87], v4 offset:3072
    s_add_u32 s25, s25, 24576
    s_cmp_eq_u32 s25, 147456
    s_cselect_b32 s25, 0, s25
    s_waitcnt lgkmcnt(9)
    v_mfma_f32_32x32x16_bf16 v[24:39], v[56:59], v[72:75], v[24:39]
    s_waitcnt lgkmcnt(6)
    v_mfma_f32_32x32x16_bf16 v[24:39], v[60:63], v[76:79], v[24:39]
    s_waitcnt lgkmcnt(3)
    v_mfma_f32_32x32x16_bf16 v[24:39], v[64:67], v[80:83], v[24:39]
    s_waitcnt lgkmcnt(0)
    v_mfma_f32_32x32x16_bf16 v[24:39], v[68:71], v[84:87], v[24:39]
    s_waitcnt vmcnt(6)
    s_barrier
    v_add_u32 v3, s25, v7
    v_add_u32 v4, s25, v8
    ds_read_b64_tr_b16 v[56:57], v3 offset:0
    ds_read_b64_tr_b16 v[58:59], v3 offset:2048
    ds_read_b128 v[72:75], v4 offset:0
    ds_read_b64_tr_b16 v[60:61], v3 offset:4096
    ds_read_b64_tr_b16 v[62:63], v3 offset:6144
    ds_read_b128 v[76:79], v4 offset:1024
    ds_read_b64_tr_b16 v[64:65], v3 offset:8192
    ds_read_b64_tr_b16 v[66:67], v3 offset:10240
    ds_read_b128 v[80:83], v4 offset:2048
    ds_read_b64_tr_b16 v[68:69], v3 offset:12288
    ds_read_b64_tr_b16 v[70:71], v3 offset:14336
    ds_read_b128 v[84:87], v4 offset:3072
    s_add_u32 s25, s25, 24576
    s_cmp_eq_u32 s25, 147456
    s_cselect_b32 s25, 0, s25
    s_waitcnt lgkmcnt(9)
    v_mfma_f32_32x32x16_bf16 v[24:39], v[56:59], v[72:75], v[24:39]
    s_waitcnt lgkmcnt(6)
    v_mfma_f32_32x32x16_bf16 v[24:39], v[60:63], v[76:79], v[24:39]
    s_waitcnt lgkmcnt(3)
    v_mfma_f32_32x32x16_bf16 v[24:39], v[64:67], v[80:83], v[24:39]
    s_waitcnt lgkmcnt(0)
    v_mfma_f32_32x32x16_bf16 v[24:39], v[68:71], v[84:87], v[24:39]
    s_waitcnt vmcnt(3)
    s_barrier
    v_add_u32 v3, s25, v7
    v_add_u32 v4, s25, v8
    ds_read_b64_tr_b16 v[56:57], v3 offset:0
    ds_read_b64_tr_b16 v[58:59], v3 offset:2048
    ds_read_b128 v[72:75], v4 offset:0
    ds_read_b64_tr_b16 v[60:61], v3 offset:4096
    ds_read_b64_tr_b16 v[62:63], v3 offset:6144
    ds_read_b128 v[76:79], v4 offset:1024
    ds_read_b64_tr_b16 v[64:65], v3 offset:8192
    ds_read_b64_tr_b16 v[66:67], v3 offset:10240
    ds_read_b128 v[80:83], v4 offset:2048
    ds_read_b64_tr_b16 v[68:69], v3 offset:12288
    ds_read_b64_tr_b16 v[70:71], v3 offset:14336
    ds_read_b128 v[84:87], v4 offset:3072
    s_add_u32 s25, s25, 24576
    s_cmp_eq_u32 s25, 147456
    s_cselect_b32 s25, 0, s25
    s_waitcnt lgkmcnt(9)
    v_mfma_f32_32x32x16_bf16 v[24:39], v[56:59], v[72:75], v[24:39]
    s_waitcnt lgkmcnt(6)
    v_mfma_f32_32x32x16_bf16 v[24:39], v[60:63], v[76:79], v[24:39]
    s_waitcnt lgkmcnt(3)
    v_mfma_f32_32x32x16_bf16 v[24:39], v[64:67], v[80:83], v[24:39]
    s_waitcnt lgkmcnt(0)
    v_mfma_f32_32x32x16_bf16 v[24:39], v[68:71], v[84:87], v[24:39]
    s_waitcnt vmcnt(0)
    s_barrier
    v_add_u32 v3, s25, v7
    v_add_u32 v4, s25, v8
    ds_read_b64_tr_b16 v[56:57], v3 offset:0
    ds_read_b64_tr_b16 v[58:59], v3 offset:2048
    ds_read_b128 v[72:75], v4 offset:0
    ds_read_b64_tr_b16 v[60:61], v3 offset:4096
    ds_read_b64_tr_b16 v[62:63], v3 offset:6144
    ds_read_b128 v[76:79], v4 offset:1024
    ds_read_b64_tr_b16 v[64:65], v3 offset:8192
    ds_read_b64_tr_b16 v[66:67], v3 offset:10240
    ds_read_b128 v[80:83], v4 offset:2048
    ds_read_b64_tr_b16 v[68:69], v3 offset:12288
    ds_read_b64_tr_b16 v[70:71], v3 offset:14336
    ds_read_b128 v[84:87], v4 offset:3072
    s_add_u32 s25, s25, 24576
    s_cmp_eq_u32 s25, 147456
    s_cselect_b32 s25, 0, s25
    s_waitcnt lgkmcnt(9)
    v_mfma_f32_32x32x16_bf16 v[24:39], v[56:59], v[72:75], v[24:39]
    s_waitcnt lgkmcnt(6)
    v_mfma_f32_32x32x16_bf16 v[24:39], v[60:63], v[76:79], v[24:39]
    s_waitcnt lgkmcnt(3)
    v_mfma_f32_32x32x16_bf16 v[24:39], v[64:67], v[80:83], v[24:39]
    s_waitcnt lgkmcnt(0)
    v_mfma_f32_32x32x16_bf16 v[24:39], v[68:71], v[84:87], v[24:39]
    s_nop 11
    buffer_store_dwordx4 v[24:27], v2, s[12:15], s87 offen offset:0 sc1
    buffer_store_dwordx4 v[28:31], v2, s[12:15], s87 offen offset:1024 sc1
    buffer_store_dwordx4 v[32:35], v2, s[12:15], s87 offen offset:2048 sc1
    buffer_store_dwordx4 v[36:39], v2, s[12:15], s87 offen offset:3072 sc1
    s_waitcnt vmcnt(0)
    s_barrier
    s_cmp_lg_u32 s3, 0
    s_cbranch_scc1 L_w0_psig
    s_lshl_b32 s95, s2, 7
    s_add_u32 s95, s95, 25231360
    s_mov_b64 exec, 1
    v_mov_b32 v22, 1
    v_mov_b32 v23, 0
    buffer_store_dword v22, v23, s[12:15], s95 offen sc1
    s_mov_b64 exec, -1
L_w0_psig:
    s_branch L_fin
L_roleB:
    s_mov_b32 s20, s44
    s_and_b32 s21, s45, 0xffff
    s_mov_b32 s22, 0x700000
    s_mov_b32 s23, 0x20000
    s_mov_b32 s56, s46
    s_and_b32 s57, s47, 0xffff
    s_mov_b32 s58, 0x1000
    s_mov_b32 s59, 0x20000
    s_mov_b32 s52, s48
    s_and_b32 s53, s49, 0xffff
    s_mov_b32 s54, 0x200000
    s_mov_b32 s55, 0x20000
    s_mov_b32 s60, s50
    s_and_b32 s61, s51, 0xffff
    s_mov_b32 s62, 0x200000
    s_mov_b32 s63, 0x20000
    v_bfe_u32 v5, v1, 4, 1
    v_lshlrev_b32 v5, 2, v5
    v_and_b32 v11, 7, v1
    v_xor_b32 v11, v11, v5
    v_lshlrev_b32 v11, 4, v11
    v_lshrrev_b32 v5, 3, v1
    v_lshl_add_u32 v11, v5, 12, v11
    s_lshl_b32 s80, s3, 15
    s_lshl_b32 s38, s36, 7
    s_add_u32 s80, s80, s38
    s_lshr_b32 s38, s3, 1
    s_lshl2_add_u32 s81, s37, s38
    s_mul_i32 s81, s81, 114688
    s_and_b32 s38, s3, 1
    s_lshl_b32 s38, s38, 11
    s_add_u32 s81, s81, s38
    s_add_u32 s81, s81, 20971520
    s_lshl_b32 s86, s82, 15
    s_lshl_b32 s38, s83, 6
    s_add_u32 s86, s86, s38
    v_lshl_add_u32 v20, v15, 10, v16
    buffer_load_dwordx2 v[104:105], v20, s[52:55], s86 offen offset:0
    buffer_load_dwordx2 v[106:107], v20, s[52:55], s86 offen offset:16
    buffer_load_dwordx2 v[108:109], v20, s[52:55], s86 offen offset:32
    buffer_load_dwordx2 v[110:111], v20, s[52:55], s86 offen offset:48
    s_lshl_b32 s38, s82, 6
    v_lshlrev_b32 v5, 1, v15
    buffer_load_ushort v21, v5, s[56:59], s38 offen
    v_min_u32 v5, 27, v1
    v_lshrrev_b32 v18, 1, v5
    v_lshlrev_b32 v18, 4, v18
    v_and_b32 v5, 1, v5
    v_lshl_add_u32 v18, v5, 2, v18
    s_add_u32 s38, s37, 8
    s_lshl_b32 s38, s38, 7
    s_add_u32 s38, s38, 25198592
    v_lshl_add_u32 v18, v18, 7, s38
    s_xor_b32 s38, s2, 8
    s_lshl_b32 s38, s38, 7
    s_add_u32 s38, s38, 25231360
    v_mov_b32 v12, s38
    s_waitcnt vmcnt(0)
    s_barrier
    s_cmp_lg_u32 s3, 0
    s_cbranch_scc1 L_w0_o3
    s_lshl_b32 s95, s2, 7
    s_add_u32 s95, s95, 25165824
    s_mov_b64 exec, 1
    v_mov_b32 v22, 1
    v_mov_b32 v23, 0
    buffer_store_dword v22, v23, s[12:15], s95 offen sc1
    s_mov_b64 exec, -1
    s_mov_b32 s94, 300000
L_poll_o3:
    buffer_load_dword v19, v17, s[12:15], 0 offen sc1
    s_waitcnt vmcnt(0)
L_pchk_o3:
    v_cmp_ne_u32 vcc, 1, v19
    s_sub_u32 s94, s94, 1
    s_cbranch_vccz L_pdone_o3
    s_cmp_eq_u32 s94, 0
    s_cbranch_scc1 L_pdone_o3
    s_sleep 8
    s_branch L_poll_o3
L_pdone_o3:
L_w0_o3:
    s_barrier
    s_add_u32 m0, s24, s26
    s_add_u32 s28, s24, s27
    buffer_load_dwordx4 v13, s[8:11], s84 offen lds
    buffer_load_dwordx4 v14, s[8:11], s84 offen offset:1024 lds
    s_mov_b32 m0, s28
    s_add_u32 s84, s84, 65536
    buffer_load_dwordx4 v2, s[12:15], s85 offen lds
    s_add_u32 s85, s85, 4096
    s_add_u32 s24, s24, 24576
    s_cmp_eq_u32 s24, 147456
    s_cselect_b32 s24, 0, s24
    s_add_u32 m0, s24, s26
    s_add_u32 s28, s24, s27
    buffer_load_dwordx4 v13, s[8:11], s84 offen lds
    buffer_load_dwordx4 v14, s[8:11], s84 offen offset:1024 lds
    s_mov_b32 m0, s28
    s_add_u32 s84, s84, 65536
    buffer_load_dwordx4 v2, s[12:15], s85 offen lds
    s_add_u32 s85, s85, 4096
    s_add_u32 s24, s24, 24576
    s_cmp_eq_u32 s24, 147456
    s_cselect_b32 s24, 0, s24
    s_add_u32 m0, s24, s26
    s_add_u32 s28, s24, s27
    buffer_load_dwordx4 v13, s[8:11], s84 offen lds
    buffer_load_dwordx4 v14, s[8:11], s84 offen offset:1024 lds
    s_mov_b32 m0, s28
    s_add_u32 s84, s84, 65536
    buffer_load_dwordx4 v2, s[12:15], s85 offen lds
    s_add_u32 s85, s85, 4096
    s_add_u32 s24, s24, 24576
    s_cmp_eq_u32 s24, 147456
    s_cselect_b32 s24, 0, s24
    s_add_u32 m0, s24, s26
    s_add_u32 s28, s24, s27
    buffer_load_dwordx4 v13, s[8:11], s84 offen lds
    buffer_load_dwordx4 v14, s[8:11], s84 offen offset:1024 lds
    s_mov_b32 m0, s28
    s_add_u32 s84, s84, 65536
    buffer_load_dwordx4 v2, s[12:15], s85 offen lds
    s_add_u32 s85, s85, 4096
    s_add_u32 s24, s24, 24576
    s_cmp_eq_u32 s24, 147456
    s_cselect_b32 s24, 0, s24
    s_add_u32 m0, s24, s26
    s_add_u32 s28, s24, s27
    buffer_load_dwordx4 v13, s[8:11], s84 offen lds
    buffer_load_dwordx4 v14, s[8:11], s84 offen offset:1024 lds
    s_mov_b32 m0, s28
    s_add_u32 s84, s84, 65536
    buffer_load_dwordx4 v2, s[12:15], s85 offen lds
    s_add_u32 s85, s85, 4096
    s_add_u32 s24, s24, 24576
    s_cmp_eq_u32 s24, 147456
    s_cselect_b32 s24, 0, s24
    s_mov_b32 s30, 22
L_gb_0:
    s_waitcnt vmcnt(12)
    s_barrier
    v_add_u32 v3, s25, v7
    v_add_u32 v4, s25, v8
    ds_read_b64_tr_b16 v[56:57], v3 offset:0
    ds_read_b64_tr_b16 v[58:59], v3 offset:2048
    ds_read_b128 v[72:75], v4 offset:0
    ds_read_b64_tr_b16 v[60:61], v3 offset:4096
    ds_read_b64_tr_b16 v[62:63], v3 offset:6144
    ds_read_b128 v[76:79], v4 offset:1024
    ds_read_b64_tr_b16 v[64:65], v3 offset:8192
    ds_read_b64_tr_b16 v[66:67], v3 offset:10240
    ds_read_b128 v[80:83], v4 offset:2048
    ds_read_b64_tr_b16 v[68:69], v3 offset:12288
    ds_read_b64_tr_b16 v[70:71], v3 offset:14336
    ds_read_b128 v[84:87], v4 offset:3072
    s_add_u32 s25, s25, 24576
    s_cmp_eq_u32 s25, 147456
    s_cselect_b32 s25, 0, s25
    s_waitcnt lgkmcnt(9)
    v_mfma_f32_32x32x16_bf16 v[24:39], v[56:59], v[72:75], v[24:39]
    s_waitcnt lgkmcnt(6)
    v_mfma_f32_32x32x16_bf16 v[24:39], v[60:63], v[76:79], v[24:39]
    s_waitcnt lgkmcnt(3)
    v_mfma_f32_32x32x16_bf16 v[24:39], v[64:67], v[80:83], v[24:39]
    s_waitcnt lgkmcnt(0)
    v_mfma_f32_32x32x16_bf16 v[24:39], v[68:71], v[84:87], v[24:39]
    s_add_u32 m0, s24, s26
    s_add_u32 s28, s24, s27
    buffer_load_dwordx4 v13, s[8:11], s84 offen lds
    buffer_load_dwordx4 v14, s[8:11], s84 offen offset:1024 lds
    s_mov_b32 m0, s28
    s_add_u32 s84, s84, 65536
    buffer_load_dwordx4 v2, s[12:15], s85 offen lds
    s_add_u32 s85, s85, 4096
    s_add_u32 s24, s24, 24576
    s_cmp_eq_u32 s24, 147456
    s_cselect_b32 s24, 0, s24
    s_sub_u32 s30, s30, 1
    s_cmp_lg_u32 s30, 0
    s_cbranch_scc1 L_gb_0
    s_cmp_lg_u32 s3, 0
    s_cbranch_scc1 L_w0_usmp
    buffer_load_dword v19, v18, s[12:15], 0 offen sc1
L_w0_usmp:
    s_mov_b32 s30, 5
L_gb_1:
    s_waitcnt vmcnt(12)
    s_barrier
    v_add_u32 v3, s25, v7
    v_add_u32 v4, s25, v8
    ds_read_b64_tr_b16 v[56:57], v3 offset:0
    ds_read_b64_tr_b16 v[58:59], v3 offset:2048
    ds_read_b128 v[72:75], v4 offset:0
    ds_read_b64_tr_b16 v[60:61], v3 offset:4096
    ds_read_b64_tr_b16 v[62:63], v3 offset:6144
    ds_read_b128 v[76:79], v4 offset:1024
    ds_read_b64_tr_b16 v[64:65], v3 offset:8192
    ds_read_b64_tr_b16 v[66:67], v3 offset:10240
    ds_read_b128 v[80:83], v4 offset:2048
    ds_read_b64_tr_b16 v[68:69], v3 offset:12288
    ds_read_b64_tr_b16 v[70:71], v3 offset:14336
    ds_read_b128 v[84:87], v4 offset:3072
    s_add_u32 s25, s25, 24576
    s_cmp_eq_u32 s25, 147456
    s_cselect_b32 s25, 0, s25
    s_waitcnt lgkmcnt(9)
    v_mfma_f32_32x32x16_bf16 v[24:39], v[56:59], v[72:75], v[24:39]
    s_waitcnt lgkmcnt(6)
    v_mfma_f32_32x32x16_bf16 v[24:39], v[60:63], v[76:79], v[24:39]
    s_waitcnt lgkmcnt(3)
    v_mfma_f32_32x32x16_bf16 v[24:39], v[64:67], v[80:83], v[24:39]
    s_waitcnt lgkmcnt(0)
    v_mfma_f32_32x32x16_bf16 v[24:39], v[68:71], v[84:87], v[24:39]
    s_add_u32 m0, s24, s26
    s_add_u32 s28, s24, s27
    buffer_load_dwordx4 v13, s[8:11], s84 offen lds
    buffer_load_dwordx4 v14, s[8:11], s84 offen offset:1024 lds
    s_mov_b32 m0, s28
    s_add_u32 s84, s84, 65536
    buffer_load_dwordx4 v2, s[12:15], s85 offen lds
    s_add_u32 s85, s85, 4096
    s_add_u32 s24, s24, 24576
    s_cmp_eq_u32 s24, 147456
    s_cselect_b32 s24, 0, s24
    s_sub_u32 s30, s30, 1
    s_cmp_lg_u32 s30, 0
    s_cbranch_scc1 L_gb_1
    s_cmp_lg_u32 s3, 0
    s_cbranch_scc1 L_w0_upoll
    s_mov_b32 s94, 300000
    s_branch L_pchk_u
L_poll_u:
    buffer_load_dword v19, v18, s[12:15], 0 offen sc1
    s_waitcnt vmcnt(0)
L_pchk_u:
    v_cmp_ne_u32 vcc, 1, v19
    s_sub_u32 s94, s94, 1
    s_cbranch_vccz L_pdone_u
    s_cmp_eq_u32 s94, 0
    s_cbranch_scc1 L_pdone_u
    s_sleep 8
    s_branch L_poll_u
L_pdone_u:
L_w0_upoll:
    s_mov_b32 s30, 5
L_gb_2:
    s_waitcnt vmcnt(12)
    s_barrier
    v_add_u32 v3, s25, v7
    v_add_u32 v4, s25, v8
    ds_read_b64_tr_b16 v[56:57], v3 offset:0
    ds_read_b64_tr_b16 v[58:59], v3 offset:2048
    ds_read_b128 v[72:75], v4 offset:0
    ds_read_b64_tr_b16 v[60:61], v3 offset:4096
    ds_read_b64_tr_b16 v[62:63], v3 offset:6144
    ds_read_b128 v[76:79], v4 offset:1024
    ds_read_b64_tr_b16 v[64:65], v3 offset:8192
    ds_read_b64_tr_b16 v[66:67], v3 offset:10240
    ds_read_b128 v[80:83], v4 offset:2048
    ds_read_b64_tr_b16 v[68:69], v3 offset:12288
    ds_read_b64_tr_b16 v[70:71], v3 offset:14336
    ds_read_b128 v[84:87], v4 offset:3072
    s_add_u32 s25, s25, 24576
    s_cmp_eq_u32 s25, 147456
    s_cselect_b32 s25, 0, s25
    s_waitcnt lgkmcnt(9)
    v_mfma_f32_32x32x16_bf16 v[24:39], v[56:59], v[72:75], v[24:39]
    s_waitcnt lgkmcnt(6)
    v_mfma_f32_32x32x16_bf16 v[24:39], v[60:63], v[76:79], v[24:39]
    s_waitcnt lgkmcnt(3)
    v_mfma_f32_32x32x16_bf16 v[24:39], v[64:67], v[80:83], v[24:39]
    s_waitcnt lgkmcnt(0)
    v_mfma_f32_32x32x16_bf16 v[24:39], v[68:71], v[84:87], v[24:39]
    s_add_u32 m0, s24, s26
    s_add_u32 s28, s24, s27
    buffer_load_dwordx4 v2, s[12:15], s81 offen lds
    buffer_load_dwordx4 v2, s[12:15], s81 offen offset:1024 lds
    s_mov_b32 m0, s28
    s_nop 0
    buffer_load_dwordx4 v11, s[20:23], s80 offen lds
    s_add_u32 s80, s80, 262144
    s_add_u32 s81, s81, 4096
    s_add_u32 s24, s24, 24576
    s_cmp_eq_u32 s24, 147456
    s_cselect_b32 s24, 0, s24
    s_sub_u32 s30, s30, 1
    s_cmp_lg_u32 s30, 0
    s_cbranch_scc1 L_gb_2
    s_mov_b32 s30, 23
L_y_0:
    s_waitcnt vmcnt(12)
    s_barrier
    v_add_u32 v3, s25, v9
    v_add_u32 v4, s25, v10
    ds_read_b64_tr_b16 v[56:57], v3 offset:0
    ds_read_b64_tr_b16 v[58:59], v3 offset:1024
    ds_read_b128 v[72:75], v4 offset:0
    ds_read_b64_tr_b16 v[60:61], v3 offset:2048
    ds_read_b64_tr_b16 v[62:63], v3 offset:3072
    ds_read_b128 v[76:79], v4 offset:1024
    ds_read_b64_tr_b16 v[64:65], v3 offset:4096
    ds_read_b64_tr_b16 v[66:67], v3 offset:5120
    ds_read_b128 v[80:83], v4 offset:2048
    ds_read_b64_tr_b16 v[68:69], v3 offset:6144
    ds_read_b64_tr_b16 v[70:71], v3 offset:7168
    ds_read_b128 v[84:87], v4 offset:3072
    s_add_u32 s25, s25, 24576
    s_cmp_eq_u32 s25, 147456
    s_cselect_b32 s25, 0, s25
    s_waitcnt lgkmcnt(9)
    v_mfma_f32_32x32x16_bf16 v[40:55], v[72:75], v[56:59], v[40:55]
    s_waitcnt lgkmcnt(6)
    v_mfma_f32_32x32x16_bf16 v[40:55], v[76:79], v[60:63], v[40:55]
    s_waitcnt lgkmcnt(3)
    v_mfma_f32_32x32x16_bf16 v[40:55], v[80:83], v[64:67], v[40:55]
    s_waitcnt lgkmcnt(0)
    v_mfma_f32_32x32x16_bf16 v[40:55], v[84:87], v[68:71], v[40:55]
    s_add_u32 m0, s24, s26
    s_add_u32 s28, s24, s27
    buffer_load_dwordx4 v2, s[12:15], s81 offen lds
    buffer_load_dwordx4 v2, s[12:15], s81 offen offset:1024 lds
    s_mov_b32 m0, s28
    s_nop 0
    buffer_load_dwordx4 v11, s[20:23], s80 offen lds
    s_add_u32 s80, s80, 262144
    s_add_u32 s81, s81, 4096
    s_add_u32 s24, s24, 24576
    s_cmp_eq_u32 s24, 147456
    s_cselect_b32 s24, 0, s24
    s_sub_u32 s30, s30, 1
    s_cmp_lg_u32 s30, 0
    s_cbranch_scc1 L_y_0
    s_cmp_lg_u32 s3, 0
    s_cbranch_scc1 L_w0_psmp
    buffer_load_dword v19, v12, s[12:15], 0 offen sc1
L_w0_psmp:
    s_waitcnt vmcnt(13)
    s_barrier
    v_add_u32 v3, s25, v9
    v_add_u32 v4, s25, v10
    ds_read_b64_tr_b16 v[56:57], v3 offset:0
    ds_read_b64_tr_b16 v[58:59], v3 offset:1024
    ds_read_b128 v[72:75], v4 offset:0
    ds_read_b64_tr_b16 v[60:61], v3 offset:2048
    ds_read_b64_tr_b16 v[62:63], v3 offset:3072
    ds_read_b128 v[76:79], v4 offset:1024
    ds_read_b64_tr_b16 v[64:65], v3 offset:4096
    ds_read_b64_tr_b16 v[66:67], v3 offset:5120
    ds_read_b128 v[80:83], v4 offset:2048
    ds_read_b64_tr_b16 v[68:69], v3 offset:6144
    ds_read_b64_tr_b16 v[70:71], v3 offset:7168
    ds_read_b128 v[84:87], v4 offset:3072
    s_add_u32 s25, s25, 24576
    s_cmp_eq_u32 s25, 147456
    s_cselect_b32 s25, 0, s25
    s_waitcnt lgkmcnt(9)
    v_mfma_f32_32x32x16_bf16 v[40:55], v[72:75], v[56:59], v[40:55]
    s_waitcnt lgkmcnt(6)
    v_mfma_f32_32x32x16_bf16 v[40:55], v[76:79], v[60:63], v[40:55]
    s_waitcnt lgkmcnt(3)
    v_mfma_f32_32x32x16_bf16 v[40:55], v[80:83], v[64:67], v[40:55]
    s_waitcnt lgkmcnt(0)
    v_mfma_f32_32x32x16_bf16 v[40:55], v[84:87], v[68:71], v[40:55]
    s_waitcnt vmcnt(10)
    s_barrier
    v_add_u32 v3, s25, v9
    v_add_u32 v4, s25, v10
    ds_read_b64_tr_b16 v[56:57], v3 offset:0
    ds_read_b64_tr_b16 v[58:59], v3 offset:1024
    ds_read_b128 v[72:75], v4 offset:0
    ds_read_b64_tr_b16 v[60:61], v3 offset:2048
    ds_read_b64_tr_b16 v[62:63], v3 offset:3072
    ds_read_b128 v[76:79], v4 offset:1024
    ds_read_b64_tr_b16 v[64:65], v3 offset:4096
    ds_read_b64_tr_b16 v[66:67], v3 offset:5120
    ds_read_b128 v[80:83], v4 offset:2048
    ds_read_b64_tr_b16 v[68:69], v3 offset:6144
    ds_read_b64_tr_b16 v[70:71], v3 offset:7168
    ds_read_b128 v[84:87], v4 offset:3072
    s_add_u32 s25, s25, 24576
    s_cmp_eq_u32 s25, 147456
    s_cselect_b32 s25, 0, s25
    s_waitcnt lgkmcnt(9)
    v_mfma_f32_32x32x16_bf16 v[40:55], v[72:75], v[56:59], v[40:55]
    s_waitcnt lgkmcnt(6)
    v_mfma_f32_32x32x16_bf16 v[40:55], v[76:79], v[60:63], v[40:55]
    s_waitcnt lgkmcnt(3)
    v_mfma_f32_32x32x16_bf16 v[40:55], v[80:83], v[64:67], v[40:55]
    s_waitcnt lgkmcnt(0)
    v_mfma_f32_32x32x16_bf16 v[40:55], v[84:87], v[68:71], v[40:55]
    s_waitcnt vmcnt(7)
    s_barrier
    v_add_u32 v3, s25, v9
    v_add_u32 v4, s25, v10
    ds_read_b64_tr_b16 v[56:57], v3 offset:0
    ds_read_b64_tr_b16 v[58:59], v3 offset:1024
    ds_read_b128 v[72:75], v4 offset:0
    ds_read_b64_tr_b16 v[60:61], v3 offset:2048
    ds_read_b64_tr_b16 v[62:63], v3 offset:3072
    ds_read_b128 v[76:79], v4 offset:1024
    ds_read_b64_tr_b16 v[64:65], v3 offset:4096
    ds_read_b64_tr_b16 v[66:67], v3 offset:5120
    ds_read_b128 v[80:83], v4 offset:2048
    ds_read_b64_tr_b16 v[68:69], v3 offset:6144
    ds_read_b64_tr_b16 v[70:71], v3 offset:7168
    ds_read_b128 v[84:87], v4 offset:3072
    s_add_u32 s25, s25, 24576
    s_cmp_eq_u32 s25, 147456
    s_cselect_b32 s25, 0, s25
    s_waitcnt lgkmcnt(9)
    v_mfma_f32_32x32x16_bf16 v[40:55], v[72:75], v[56:59], v[40:55]
    s_waitcnt lgkmcnt(6)
    v_mfma_f32_32x32x16_bf16 v[40:55], v[76:79], v[60:63], v[40:55]
    s_waitcnt lgkmcnt(3)
    v_mfma_f32_32x32x16_bf16 v[40:55], v[80:83], v[64:67], v[40:55]
    s_waitcnt lgkmcnt(0)
    v_mfma_f32_32x32x16_bf16 v[40:55], v[84:87], v[68:71], v[40:55]
    s_waitcnt vmcnt(0)
    s_cmp_lg_u32 s3, 0
    s_cbranch_scc1 L_w0_ppoll
    s_mov_b32 s94, 300000
    s_branch L_pchk_p
L_poll_p:
    buffer_load_dword v19, v12, s[12:15], 0 offen sc1
    s_waitcnt vmcnt(0)
L_pchk_p:
    v_cmp_ne_u32 vcc, 1, v19
    s_sub_u32 s94, s94, 1
    s_cbranch_vccz L_pdone_p
    s_cmp_eq_u32 s94, 0
    s_cbranch_scc1 L_pdone_p
    s_sleep 8
    s_branch L_poll_p
L_pdone_p:
L_w0_ppoll:
    s_waitcnt vmcnt(3)
    s_barrier
    v_add_u32 v3, s25, v9
    v_add_u32 v4, s25, v10
    ds_read_b64_tr_b16 v[56:57], v3 offset:0
    ds_read_b64_tr_b16 v[58:59], v3 offset:1024
    ds_read_b128 v[72:75], v4 offset:0
    ds_read_b64_tr_b16 v[60:61], v3 offset:2048
    ds_read_b64_tr_b16 v[62:63], v3 offset:3072
    ds_read_b128 v[76:79], v4 offset:1024
    ds_read_b64_tr_b16 v[64:65], v3 offset:4096
    ds_read_b64_tr_b16 v[66:67], v3 offset:5120
    ds_read_b128 v[80:83], v4 offset:2048
    ds_read_b64_tr_b16 v[68:69], v3 offset:6144
    ds_read_b64_tr_b16 v[70:71], v3 offset:7168
    ds_read_b128 v[84:87], v4 offset:3072
    s_add_u32 s25, s25, 24576
    s_cmp_eq_u32 s25, 147456
    s_cselect_b32 s25, 0, s25
    s_waitcnt lgkmcnt(9)
    v_mfma_f32_32x32x16_bf16 v[40:55], v[72:75], v[56:59], v[40:55]
    s_waitcnt lgkmcnt(6)
    v_mfma_f32_32x32x16_bf16 v[40:55], v[76:79], v[60:63], v[40:55]
    s_waitcnt lgkmcnt(3)
    v_mfma_f32_32x32x16_bf16 v[40:55], v[80:83], v[64:67], v[40:55]
    s_waitcnt lgkmcnt(0)
    v_mfma_f32_32x32x16_bf16 v[40:55], v[84:87], v[68:71], v[40:55]
    buffer_load_dwordx4 v[112:115], v2, s[12:15], s87 offen offset:0 sc1
    buffer_load_dwordx4 v[116:119], v2, s[12:15], s87 offen offset:1024 sc1
    buffer_load_dwordx4 v[120:123], v2, s[12:15], s87 offen offset:2048 sc1
    buffer_load_dwordx4 v[124:127], v2, s[12:15], s87 offen offset:3072 sc1
    s_waitcnt vmcnt(4)
    s_barrier
    v_add_u32 v3, s25, v9
    v_add_u32 v4, s25, v10
    ds_read_b64_tr_b16 v[56:57], v3 offset:0
    ds_read_b64_tr_b16 v[58:59], v3 offset:1024
    ds_read_b128 v[72:75], v4 offset:0
    ds_read_b64_tr_b16 v[60:61], v3 offset:2048
    ds_read_b64_tr_b16 v[62:63], v3 offset:3072
    ds_read_b128 v[76:79], v4 offset:1024
    ds_read_b64_tr_b16 v[64:65], v3 offset:4096
    ds_read_b64_tr_b16 v[66:67], v3 offset:5120
    ds_read_b128 v[80:83], v4 offset:2048
    ds_read_b64_tr_b16 v[68:69], v3 offset:6144
    ds_read_b64_tr_b16 v[70:71], v3 offset:7168
    ds_read_b128 v[84:87], v4 offset:3072
    s_add_u32 s25, s25, 24576
    s_cmp_eq_u32 s25, 147456
    s_cselect_b32 s25, 0, s25
    s_waitcnt lgkmcnt(9)
    v_mfma_f32_32x32x16_bf16 v[40:55], v[72:75], v[56:59], v[40:55]
    s_waitcnt lgkmcnt(6)
    v_mfma_f32_32x32x16_bf16 v[40:55], v[76:79], v[60:63], v[40:55]
    s_waitcnt lgkmcnt(3)
    v_mfma_f32_32x32x16_bf16 v[40:55], v[80:83], v[64:67], v[40:55]
    s_waitcnt lgkmcnt(0)
    v_mfma_f32_32x32x16_bf16 v[40:55], v[84:87], v[68:71], v[40:55]
    s_waitcnt vmcnt(0)
    s_nop 10
    v_cvt_pk_bf16_f32 v72, v40, v41
    v_cvt_pk_bf16_f32 v73, v42, v43
    v_cvt_pk_bf16_f32 v74, v44, v45
    v_cvt_pk_bf16_f32 v75, v46, v47
    v_lshlrev_b32 v40, 16, v72
    v_and_b32 v41, 0xffff0000, v72
    v_lshlrev_b32 v42, 16, v73
    v_and_b32 v43, 0xffff0000, v73
    v_lshlrev_b32 v44, 16, v74
    v_and_b32 v45, 0xffff0000, v74
    v_lshlrev_b32 v46, 16, v75
    v_and_b32 v47, 0xffff0000, v75
    v_cvt_pk_bf16_f32 v76, v48, v49
    v_cvt_pk_bf16_f32 v77, v50, v51
    v_cvt_pk_bf16_f32 v78, v52, v53
    v_cvt_pk_bf16_f32 v79, v54, v55
    v_lshlrev_b32 v48, 16, v76
    v_and_b32 v49, 0xffff0000, v76
    v_lshlrev_b32 v50, 16, v77
    v_and_b32 v51, 0xffff0000, v77
    v_lshlrev_b32 v52, 16, v78
    v_and_b32 v53, 0xffff0000, v78
    v_lshlrev_b32 v54, 16, v79
    v_and_b32 v55, 0xffff0000, v79
    v_lshlrev_b32 v21, 16, v21
    v_add_f32 v40, v40, v21
    v_add_f32 v41, v41, v21
    v_add_f32 v42, v42, v21
    v_add_f32 v43, v43, v21
    v_add_f32 v44, v44, v21
    v_add_f32 v45, v45, v21
    v_add_f32 v46, v46, v21
    v_add_f32 v47, v47, v21
    v_add_f32 v48, v48, v21
    v_add_f32 v49, v49, v21
    v_add_f32 v50, v50, v21
    v_add_f32 v51, v51, v21
    v_add_f32 v52, v52, v21
    v_add_f32 v53, v53, v21
    v_add_f32 v54, v54, v21
    v_add_f32 v55, v55, v21
    v_cvt_pk_bf16_f32 v72, v40, v41
    v_cvt_pk_bf16_f32 v73, v42, v43
    v_cvt_pk_bf16_f32 v74, v44, v45
    v_cvt_pk_bf16_f32 v75, v46, v47
    v_lshlrev_b32 v40, 16, v72
    v_and_b32 v41, 0xffff0000, v72
    v_lshlrev_b32 v42, 16, v73
    v_and_b32 v43, 0xffff0000, v73
    v_lshlrev_b32 v44, 16, v74
    v_and_b32 v45, 0xffff0000, v74
    v_lshlrev_b32 v46, 16, v75
    v_and_b32 v47, 0xffff0000, v75
    v_cvt_pk_bf16_f32 v76, v48, v49
    v_cvt_pk_bf16_f32 v77, v50, v51
    v_cvt_pk_bf16_f32 v78, v52, v53
    v_cvt_pk_bf16_f32 v79, v54, v55
    v_lshlrev_b32 v48, 16, v76
    v_and_b32 v49, 0xffff0000, v76
    v_lshlrev_b32 v50, 16, v77
    v_and_b32 v51, 0xffff0000, v77
    v_lshlrev_b32 v52, 16, v78
    v_and_b32 v53, 0xffff0000, v78
    v_lshlrev_b32 v54, 16, v79
    v_and_b32 v55, 0xffff0000, v79
    v_mul_f32 v88, 0xbfb8aa3b, v40
    v_mul_f32 v89, 0xbfb8aa3b, v41
    v_mul_f32 v90, 0xbfb8aa3b, v42
    v_mul_f32 v91, 0xbfb8aa3b, v43
    v_mul_f32 v92, 0xbfb8aa3b, v44
    v_mul_f32 v93, 0xbfb8aa3b, v45
    v_mul_f32 v94, 0xbfb8aa3b, v46
    v_mul_f32 v95, 0xbfb8aa3b, v47
    v_mul_f32 v96, 0xbfb8aa3b, v48
    v_mul_f32 v97, 0xbfb8aa3b, v49
    v_mul_f32 v98, 0xbfb8aa3b, v50
    v_mul_f32 v99, 0xbfb8aa3b, v51
    v_mul_f32 v100, 0xbfb8aa3b, v52
    v_mul_f32 v101, 0xbfb8aa3b, v53
    v_mul_f32 v102, 0xbfb8aa3b, v54
    v_mul_f32 v103, 0xbfb8aa3b, v55
    v_exp_f32 v88, v88
    v_exp_f32 v89, v89
    v_exp_f32 v90, v90
    v_exp_f32 v91, v91
    v_exp_f32 v92, v92
    v_exp_f32 v93, v93
    v_exp_f32 v94, v94
    v_exp_f32 v95, v95
    v_exp_f32 v96, v96
    v_exp_f32 v97, v97
    v_exp_f32 v98, v98
    v_exp_f32 v99, v99
    v_exp_f32 v100, v100
    v_exp_f32 v101, v101
    v_exp_f32 v102, v102
    v_exp_f32 v103, v103
    v_add_f32 v88, 1.0, v88
    v_add_f32 v89, 1.0, v89
    v_add_f32 v90, 1.0, v90
    v_add_f32 v91, 1.0, v91
    v_add_f32 v92, 1.0, v92
    v_add_f32 v93, 1.0, v93
    v_add_f32 v94, 1.0, v94
    v_add_f32 v95, 1.0, v95
    v_add_f32 v96, 1.0, v96
    v_add_f32 v97, 1.0, v97
    v_add_f32 v98, 1.0, v98
    v_add_f32 v99, 1.0, v99
    v_add_f32 v100, 1.0, v100
    v_add_f32 v101, 1.0, v101
    v_add_f32 v102, 1.0, v102
    v_add_f32 v103, 1.0, v103
    v_rcp_f32 v88, v88
    v_rcp_f32 v89, v89
    v_rcp_f32 v90, v90
    v_rcp_f32 v91, v91
    v_rcp_f32 v92, v92
    v_rcp_f32 v93, v93
    v_rcp_f32 v94, v94
    v_rcp_f32 v95, v95
    v_rcp_f32 v96, v96
    v_rcp_f32 v97, v97
    v_rcp_f32 v98, v98
    v_rcp_f32 v99, v99
    v_rcp_f32 v100, v100
    v_rcp_f32 v101, v101
    v_rcp_f32 v102, v102
    v_rcp_f32 v103, v103
    v_mul_f32 v40, v40, v88
    v_mul_f32 v41, v41, v89
    v_mul_f32 v42, v42, v90
    v_mul_f32 v43, v43, v91
    v_mul_f32 v44, v44, v92
    v_mul_f32 v45, v45, v93
    v_mul_f32 v46, v46, v94
    v_mul_f32 v47, v47, v95
    v_mul_f32 v48, v48, v96
    v_mul_f32 v49, v49, v97
    v_mul_f32 v50, v50, v98
    v_mul_f32 v51, v51, v99
    v_mul_f32 v52, v52, v100
    v_mul_f32 v53, v53, v101
    v_mul_f32 v54, v54, v102
    v_mul_f32 v55, v55, v103
    v_cvt_pk_bf16_f32 v72, v40, v41
    v_cvt_pk_bf16_f32 v73, v42, v43
    v_cvt_pk_bf16_f32 v74, v44, v45
    v_cvt_pk_bf16_f32 v75, v46, v47
    v_lshlrev_b32 v40, 16, v72
    v_and_b32 v41, 0xffff0000, v72
    v_lshlrev_b32 v42, 16, v73
    v_and_b32 v43, 0xffff0000, v73
    v_lshlrev_b32 v44, 16, v74
    v_and_b32 v45, 0xffff0000, v74
    v_lshlrev_b32 v46, 16, v75
    v_and_b32 v47, 0xffff0000, v75
    v_cvt_pk_bf16_f32 v76, v48, v49
    v_cvt_pk_bf16_f32 v77, v50, v51
    v_cvt_pk_bf16_f32 v78, v52, v53
    v_cvt_pk_bf16_f32 v79, v54, v55
    v_lshlrev_b32 v48, 16, v76
    v_and_b32 v49, 0xffff0000, v76
    v_lshlrev_b32 v50, 16, v77
    v_and_b32 v51, 0xffff0000, v77
    v_lshlrev_b32 v52, 16, v78
    v_and_b32 v53, 0xffff0000, v78
    v_lshlrev_b32 v54, 16, v79
    v_and_b32 v55, 0xffff0000, v79
    v_add_f32 v24, v24, v112
    v_add_f32 v25, v25, v113
    v_add_f32 v26, v26, v114
    v_add_f32 v27, v27, v115
    v_add_f32 v28, v28, v116
    v_add_f32 v29, v29, v117
    v_add_f32 v30, v30, v118
    v_add_f32 v31, v31, v119
    v_add_f32 v32, v32, v120
    v_add_f32 v33, v33, v121
    v_add_f32 v34, v34, v122
    v_add_f32 v35, v35, v123
    v_add_f32 v36, v36, v124
    v_add_f32 v37, v37, v125
    v_add_f32 v38, v38, v126
    v_add_f32 v39, v39, v127
    v_cvt_pk_bf16_f32 v72, v24, v25
    v_cvt_pk_bf16_f32 v73, v26, v27
    v_cvt_pk_bf16_f32 v74, v28, v29
    v_cvt_pk_bf16_f32 v75, v30, v31
    v_lshlrev_b32 v24, 16, v72
    v_and_b32 v25, 0xffff0000, v72
    v_lshlrev_b32 v26, 16, v73
    v_and_b32 v27, 0xffff0000, v73
    v_lshlrev_b32 v28, 16, v74
    v_and_b32 v29, 0xffff0000, v74
    v_lshlrev_b32 v30, 16, v75
    v_and_b32 v31, 0xffff0000, v75
    v_cvt_pk_bf16_f32 v76, v32, v33
    v_cvt_pk_bf16_f32 v77, v34, v35
    v_cvt_pk_bf16_f32 v78, v36, v37
    v_cvt_pk_bf16_f32 v79, v38, v39
    v_lshlrev_b32 v32, 16, v76
    v_and_b32 v33, 0xffff0000, v76
    v_lshlrev_b32 v34, 16, v77
    v_and_b32 v35, 0xffff0000, v77
    v_lshlrev_b32 v36, 16, v78
    v_and_b32 v37, 0xffff0000, v78
    v_lshlrev_b32 v38, 16, v79
    v_and_b32 v39, 0xffff0000, v79
    v_mul_f32 v24, v24, v40
    v_mul_f32 v25, v25, v41
    v_mul_f32 v26, v26, v42
    v_mul_f32 v27, v27, v43
    v_mul_f32 v28, v28, v44
    v_mul_f32 v29, v29, v45
    v_mul_f32 v30, v30, v46
    v_mul_f32 v31, v31, v47
    v_mul_f32 v32, v32, v48
    v_mul_f32 v33, v33, v49
    v_mul_f32 v34, v34, v50
    v_mul_f32 v35, v35, v51
    v_mul_f32 v36, v36, v52
    v_mul_f32 v37, v37, v53
    v_mul_f32 v38, v38, v54
    v_mul_f32 v39, v39, v55
    v_cvt_pk_bf16_f32 v72, v24, v25
    v_cvt_pk_bf16_f32 v73, v26, v27
    v_cvt_pk_bf16_f32 v74, v28, v29
    v_cvt_pk_bf16_f32 v75, v30, v31
    v_lshlrev_b32 v24, 16, v72
    v_and_b32 v25, 0xffff0000, v72
    v_lshlrev_b32 v26, 16, v73
    v_and_b32 v27, 0xffff0000, v73
    v_lshlrev_b32 v28, 16, v74
    v_and_b32 v29, 0xffff0000, v74
    v_lshlrev_b32 v30, 16, v75
    v_and_b32 v31, 0xffff0000, v75
    v_cvt_pk_bf16_f32 v76, v32, v33
    v_cvt_pk_bf16_f32 v77, v34, v35
    v_cvt_pk_bf16_f32 v78, v36, v37
    v_cvt_pk_bf16_f32 v79, v38, v39
    v_lshlrev_b32 v32, 16, v76
    v_and_b32 v33, 0xffff0000, v76
    v_lshlrev_b32 v34, 16, v77
    v_and_b32 v35, 0xffff0000, v77
    v_lshlrev_b32 v36, 16, v78
    v_and_b32 v37, 0xffff0000, v78
    v_lshlrev_b32 v38, 16, v79
    v_and_b32 v39, 0xffff0000, v79
    v_lshlrev_b32 v88, 16, v104
    v_and_b32 v89, 0xffff0000, v104
    v_lshlrev_b32 v90, 16, v105
    v_and_b32 v91, 0xffff0000, v105
    v_lshlrev_b32 v92, 16, v106
    v_and_b32 v93, 0xffff0000, v106
    v_lshlrev_b32 v94, 16, v107
    v_and_b32 v95, 0xffff0000, v107
    v_lshlrev_b32 v96, 16, v108
    v_and_b32 v97, 0xffff0000, v108
    v_lshlrev_b32 v98, 16, v109
    v_and_b32 v99, 0xffff0000, v109
    v_lshlrev_b32 v100, 16, v110
    v_and_b32 v101, 0xffff0000, v110
    v_lshlrev_b32 v102, 16, v111
    v_and_b32 v103, 0xffff0000, v111
    v_add_f32 v24, v24, v88
    v_add_f32 v25, v25, v89
    v_add_f32 v26, v26, v90
    v_add_f32 v27, v27, v91
    v_add_f32 v28, v28, v92
    v_add_f32 v29, v29, v93
    v_add_f32 v30, v30, v94
    v_add_f32 v31, v31, v95
    v_add_f32 v32, v32, v96
    v_add_f32 v33, v33, v97
    v_add_f32 v34, v34, v98
    v_add_f32 v35, v35, v99
    v_add_f32 v36, v36, v100
    v_add_f32 v37, v37, v101
    v_add_f32 v38, v38, v102
    v_add_f32 v39, v39, v103
    v_cvt_pk_bf16_f32 v72, v24, v25
    v_cvt_pk_bf16_f32 v73, v26, v27
    v_cvt_pk_bf16_f32 v74, v28, v29
    v_cvt_pk_bf16_f32 v75, v30, v31
    v_cvt_pk_bf16_f32 v76, v32, v33
    v_cvt_pk_bf16_f32 v77, v34, v35
    v_cvt_pk_bf16_f32 v78, v36, v37
    v_cvt_pk_bf16_f32 v79, v38, v39
    buffer_store_dwordx2 v[72:73], v20, s[60:63], s86 offen offset:0
    buffer_store_dwordx2 v[74:75], v20, s[60:63], s86 offen offset:16
    buffer_store_dwordx2 v[76:77], v20, s[60:63], s86 offen offset:32
    buffer_store_dwordx2 v[78:79], v20, s[60:63], s86 offen offset:48
L_fin:
L_done:
    s_endpgm
L_resc_e:
    s_nop 15
    v_max_f32 v13, 0, v13
    v_sub_f32 v14, 0, v13
    v_exp_f32 v14, v14
    v_sub_f32 v112, v112, v13
    v_sub_f32 v224, v224, v13
    v_sub_f32 v225, v225, v13
    v_sub_f32 v226, v226, v13
    v_sub_f32 v227, v227, v13
    v_sub_f32 v228, v228, v13
    v_sub_f32 v229, v229, v13
    v_sub_f32 v230, v230, v13
    v_sub_f32 v231, v231, v13
    v_sub_f32 v232, v232, v13
    v_sub_f32 v233, v233, v13
    v_sub_f32 v234, v234, v13
    v_sub_f32 v235, v235, v13
    v_sub_f32 v236, v236, v13
    v_sub_f32 v237, v237, v13
    v_sub_f32 v238, v238, v13
    v_sub_f32 v239, v239, v13
    v_sub_f32 v240, v240, v13
    v_sub_f32 v241, v241, v13
    v_sub_f32 v242, v242, v13
    v_sub_f32 v243, v243, v13
    v_sub_f32 v244, v244, v13
    v_sub_f32 v245, v245, v13
    v_sub_f32 v246, v246, v13
    v_sub_f32 v247, v247, v13
    v_sub_f32 v248, v248, v13
    v_sub_f32 v249, v249, v13
    v_sub_f32 v250, v250, v13
    v_sub_f32 v251, v251, v13
    v_sub_f32 v252, v252, v13
    v_sub_f32 v253, v253, v13
    v_sub_f32 v254, v254, v13
    v_sub_f32 v255, v255, v13
    v_mov_b32 v113, v112
    v_mov_b32 v114, v112
    v_mov_b32 v115, v112
    v_mov_b32 v116, v112
    v_mov_b32 v117, v112
    v_mov_b32 v118, v112
    v_mov_b32 v119, v112
    v_mov_b32 v120, v112
    v_mov_b32 v121, v112
    v_mov_b32 v122, v112
    v_mov_b32 v123, v112
    v_mov_b32 v124, v112
    v_mov_b32 v125, v112
    v_mov_b32 v126, v112
    v_mov_b32 v127, v112
    v_mul_f32 v11, v11, v14
    v_mul_f32 v12, v12, v14
    v_mul_f32 v128, v128, v14
    v_mul_f32 v129, v129, v14
    v_mul_f32 v130, v130, v14
    v_mul_f32 v131, v131, v14
    v_mul_f32 v132, v132, v14
    v_mul_f32 v133, v133, v14
    v_mul_f32 v134, v134, v14
    v_mul_f32 v135, v135, v14
    v_mul_f32 v136, v136, v14
    v_mul_f32 v137, v137, v14
    v_mul_f32 v138, v138, v14
    v_mul_f32 v139, v139, v14
    v_mul_f32 v140, v140, v14
    v_mul_f32 v141, v141, v14
    v_mul_f32 v142, v142, v14
    v_mul_f32 v143, v143, v14
    v_mul_f32 v144, v144, v14
    v_mul_f32 v145, v145, v14
    v_mul_f32 v146, v146, v14
    v_mul_f32 v147, v147, v14
    v_mul_f32 v148, v148, v14
    v_mul_f32 v149, v149, v14
    v_mul_f32 v150, v150, v14
    v_mul_f32 v151, v151, v14
    v_mul_f32 v152, v152, v14
    v_mul_f32 v153, v153, v14
    v_mul_f32 v154, v154, v14
    v_mul_f32 v155, v155, v14
    v_mul_f32 v156, v156, v14
    v_mul_f32 v157, v157, v14
    v_mul_f32 v158, v158, v14
    v_mul_f32 v159, v159, v14
    v_mul_f32 v160, v160, v14
    v_mul_f32 v161, v161, v14
    v_mul_f32 v162, v162, v14
    v_mul_f32 v163, v163, v14
    v_mul_f32 v164, v164, v14
    v_mul_f32 v165, v165, v14
    v_mul_f32 v166, v166, v14
    v_mul_f32 v167, v167, v14
    v_mul_f32 v168, v168, v14
    v_mul_f32 v169, v169, v14
    v_mul_f32 v170, v170, v14
    v_mul_f32 v171, v171, v14
    v_mul_f32 v172, v172, v14
    v_mul_f32 v173, v173, v14
    v_mul_f32 v174, v174, v14
    v_mul_f32 v175, v175, v14
    v_mul_f32 v176, v176, v14
    v_mul_f32 v177, v177, v14
    v_mul_f32 v178, v178, v14
    v_mul_f32 v179, v179, v14
    v_mul_f32 v180, v180, v14
    v_mul_f32 v181, v181, v14
    v_mul_f32 v182, v182, v14
    v_mul_f32 v183, v183, v14
    v_mul_f32 v184, v184, v14
    v_mul_f32 v185, v185, v14
    v_mul_f32 v186, v186, v14
    v_mul_f32 v187, v187, v14
    v_mul_f32 v188, v188, v14
    v_mul_f32 v189, v189, v14
    v_mul_f32 v190, v190, v14
    v_mul_f32 v191, v191, v14
    s_nop 1
    s_branch L_back_e
L_resc_o:
    s_nop 15
    v_max_f32 v13, 0, v13
    v_sub_f32 v14, 0, v13
    v_exp_f32 v14, v14
    v_sub_f32 v112, v112, v13
    v_sub_f32 v192, v192, v13
    v_sub_f32 v193, v193, v13
    v_sub_f32 v194, v194, v13
    v_sub_f32 v195, v195, v13
    v_sub_f32 v196, v196, v13
    v_sub_f32 v197, v197, v13
    v_sub_f32 v198, v198, v13
    v_sub_f32 v199, v199, v13
    v_sub_f32 v200, v200, v13
    v_sub_f32 v201, v201, v13
    v_sub_f32 v202, v202, v13
    v_sub_f32 v203, v203, v13
    v_sub_f32 v204, v204, v13
    v_sub_f32 v205, v205, v13
    v_sub_f32 v206, v206, v13
    v_sub_f32 v207, v207, v13
    v_sub_f32 v208, v208, v13
    v_sub_f32 v209, v209, v13
    v_sub_f32 v210, v210, v13
    v_sub_f32 v211, v211, v13
    v_sub_f32 v212, v212, v13
    v_sub_f32 v213, v213, v13
    v_sub_f32 v214, v214, v13
    v_sub_f32 v215, v215, v13
    v_sub_f32 v216, v216, v13
    v_sub_f32 v217, v217, v13
    v_sub_f32 v218, v218, v13
    v_sub_f32 v219, v219, v13
    v_sub_f32 v220, v220, v13
    v_sub_f32 v221, v221, v13
    v_sub_f32 v222, v222, v13
    v_sub_f32 v223, v223, v13
    v_mov_b32 v113, v112
    v_mov_b32 v114, v112
    v_mov_b32 v115, v112
    v_mov_b32 v116, v112
    v_mov_b32 v117, v112
    v_mov_b32 v118, v112
    v_mov_b32 v119, v112
    v_mov_b32 v120, v112
    v_mov_b32 v121, v112
    v_mov_b32 v122, v112
    v_mov_b32 v123, v112
    v_mov_b32 v124, v112
    v_mov_b32 v125, v112
    v_mov_b32 v126, v112
    v_mov_b32 v127, v112
    v_mul_f32 v11, v11, v14
    v_mul_f32 v12, v12, v14
    v_mul_f32 v128, v128, v14
    v_mul_f32 v129, v129, v14
    v_mul_f32 v130, v130, v14
    v_mul_f32 v131, v131, v14
    v_mul_f32 v132, v132, v14
    v_mul_f32 v133, v133, v14
    v_mul_f32 v134, v134, v14
    v_mul_f32 v135, v135, v14
    v_mul_f32 v136, v136, v14
    v_mul_f32 v137, v137, v14
    v_mul_f32 v138, v138, v14
    v_mul_f32 v139, v139, v14
    v_mul_f32 v140, v140, v14
    v_mul_f32 v141, v141, v14
    v_mul_f32 v142, v142, v14
    v_mul_f32 v143, v143, v14
    v_mul_f32 v144, v144, v14
    v_mul_f32 v145, v145, v14
    v_mul_f32 v146, v146, v14
    v_mul_f32 v147, v147, v14
    v_mul_f32 v148, v148, v14
    v_mul_f32 v149, v149, v14
    v_mul_f32 v150, v150, v14
    v_mul_f32 v151, v151, v14
    v_mul_f32 v152, v152, v14
    v_mul_f32 v153, v153, v14
    v_mul_f32 v154, v154, v14
    v_mul_f32 v155, v155, v14
    v_mul_f32 v156, v156, v14
    v_mul_f32 v157, v157, v14
    v_mul_f32 v158, v158, v14
    v_mul_f32 v159, v159, v14
    v_mul_f32 v160, v160, v14
    v_mul_f32 v161, v161, v14
    v_mul_f32 v162, v162, v14
    v_mul_f32 v163, v163, v14
    v_mul_f32 v164, v164, v14
    v_mul_f32 v165, v165, v14
    v_mul_f32 v166, v166, v14
    v_mul_f32 v167, v167, v14
    v_mul_f32 v168, v168, v14
    v_mul_f32 v169, v169, v14
    v_mul_f32 v170, v170, v14
    v_mul_f32 v171, v171, v14
    v_mul_f32 v172, v172, v14
    v_mul_f32 v173, v173, v14
    v_mul_f32 v174, v174, v14
    v_mul_f32 v175, v175, v14
    v_mul_f32 v176, v176, v14
    v_mul_f32 v177, v177, v14
    v_mul_f32 v178, v178, v14
    v_mul_f32 v179, v179, v14
    v_mul_f32 v180, v180, v14
    v_mul_f32 v181, v181, v14
    v_mul_f32 v182, v182, v14
    v_mul_f32 v183, v183, v14
    v_mul_f32 v184, v184, v14
    v_mul_f32 v185, v185, v14
    v_mul_f32 v186, v186, v14
    v_mul_f32 v187, v187, v14
    v_mul_f32 v188, v188, v14
    v_mul_f32 v189, v189, v14
    v_mul_f32 v190, v190, v14
    v_mul_f32 v191, v191, v14
    s_nop 1
    s_branch L_back_o
L_resc_p:
    s_nop 15
    v_max_f32 v13, 0, v13
    v_sub_f32 v14, 0, v13
    v_exp_f32 v14, v14
    v_sub_f32 v112, v112, v13
    v_sub_f32 v224, v224, v13
    v_sub_f32 v225, v225, v13
    v_sub_f32 v226, v226, v13
    v_sub_f32 v227, v227, v13
    v_sub_f32 v228, v228, v13
    v_sub_f32 v229, v229, v13
    v_sub_f32 v230, v230, v13
    v_sub_f32 v231, v231, v13
    v_sub_f32 v232, v232, v13
    v_sub_f32 v233, v233, v13
    v_sub_f32 v234, v234, v13
    v_sub_f32 v235, v235, v13
    v_sub_f32 v236, v236, v13
    v_sub_f32 v237, v237, v13
    v_sub_f32 v238, v238, v13
    v_sub_f32 v239, v239, v13
    v_sub_f32 v240, v240, v13
    v_sub_f32 v241, v241, v13
    v_sub_f32 v242, v242, v13
    v_sub_f32 v243, v243, v13
    v_sub_f32 v244, v244, v13
    v_sub_f32 v245, v245, v13
    v_sub_f32 v246, v246, v13
    v_sub_f32 v247, v247, v13
    v_sub_f32 v248, v248, v13
    v_sub_f32 v249, v249, v13
    v_sub_f32 v250, v250, v13
    v_sub_f32 v251, v251, v13
    v_sub_f32 v252, v252, v13
    v_sub_f32 v253, v253, v13
    v_sub_f32 v254, v254, v13
    v_sub_f32 v255, v255, v13
    v_mov_b32 v113, v112
    v_mov_b32 v114, v112
    v_mov_b32 v115, v112
    v_mov_b32 v116, v112
    v_mov_b32 v117, v112
    v_mov_b32 v118, v112
    v_mov_b32 v119, v112
    v_mov_b32 v120, v112
    v_mov_b32 v121, v112
    v_mov_b32 v122, v112
    v_mov_b32 v123, v112
    v_mov_b32 v124, v112
    v_mov_b32 v125, v112
    v_mov_b32 v126, v112
    v_mov_b32 v127, v112
    v_mul_f32 v11, v11, v14
    v_mul_f32 v12, v12, v14
    v_mul_f32 v128, v128, v14
    v_mul_f32 v129, v129, v14
    v_mul_f32 v130, v130, v14
    v_mul_f32 v131, v131, v14
    v_mul_f32 v132, v132, v14
    v_mul_f32 v133, v133, v14
    v_mul_f32 v134, v134, v14
    v_mul_f32 v135, v135, v14
    v_mul_f32 v136, v136, v14
    v_mul_f32 v137, v137, v14
    v_mul_f32 v138, v138, v14
    v_mul_f32 v139, v139, v14
    v_mul_f32 v140, v140, v14
    v_mul_f32 v141, v141, v14
    v_mul_f32 v142, v142, v14
    v_mul_f32 v143, v143, v14
    v_mul_f32 v144, v144, v14
    v_mul_f32 v145, v145, v14
    v_mul_f32 v146, v146, v14
    v_mul_f32 v147, v147, v14
    v_mul_f32 v148, v148, v14
    v_mul_f32 v149, v149, v14
    v_mul_f32 v150, v150, v14
    v_mul_f32 v151, v151, v14
    v_mul_f32 v152, v152, v14
    v_mul_f32 v153, v153, v14
    v_mul_f32 v154, v154, v14
    v_mul_f32 v155, v155, v14
    v_mul_f32 v156, v156, v14
    v_mul_f32 v157, v157, v14
    v_mul_f32 v158, v158, v14
    v_mul_f32 v159, v159, v14
    v_mul_f32 v160, v160, v14
    v_mul_f32 v161, v161, v14
    v_mul_f32 v162, v162, v14
    v_mul_f32 v163, v163, v14
    v_mul_f32 v164, v164, v14
    v_mul_f32 v165, v165, v14
    v_mul_f32 v166, v166, v14
    v_mul_f32 v167, v167, v14
    v_mul_f32 v168, v168, v14
    v_mul_f32 v169, v169, v14
    v_mul_f32 v170, v170, v14
    v_mul_f32 v171, v171, v14
    v_mul_f32 v172, v172, v14
    v_mul_f32 v173, v173, v14
    v_mul_f32 v174, v174, v14
    v_mul_f32 v175, v175, v14
    v_mul_f32 v176, v176, v14
    v_mul_f32 v177, v177, v14
    v_mul_f32 v178, v178, v14
    v_mul_f32 v179, v179, v14
    v_mul_f32 v180, v180, v14
    v_mul_f32 v181, v181, v14
    v_mul_f32 v182, v182, v14
    v_mul_f32 v183, v183, v14
    v_mul_f32 v184, v184, v14
    v_mul_f32 v185, v185, v14
    v_mul_f32 v186, v186, v14
    v_mul_f32 v187, v187, v14
    v_mul_f32 v188, v188, v14
    v_mul_f32 v189, v189, v14
    v_mul_f32 v190, v190, v14
    v_mul_f32 v191, v191, v14
    s_nop 1
    s_branch L_back_p
.section .rodata,"a"
.p2align 6
.amdhsa_kernel main_kernel
  .amdhsa_next_free_vgpr 256
  .amdhsa_next_free_sgpr 96
  .amdhsa_accum_offset 256
  .amdhsa_group_segment_fixed_size 0
  .amdhsa_kernarg_size 104
  .amdhsa_user_sgpr_count 2
  .amdhsa_user_sgpr_kernarg_segment_ptr 1
  .amdhsa_system_sgpr_workgroup_id_x 1
.end_amdhsa_kernel
```
